```python
import torch

def _softmax(x, axis=-1):
    return torch.softmax(x, dim=axis)
def _gelu(x):
    return torch.nn.functional.gelu(x, approximate="tanh")
def _silu(x):
    return torch.nn.functional.silu(x)
def _sigmoid(x):
    return torch.sigmoid(x)
def _layernorm(x, axis=-1, eps=1e-5):
    m = x.mean(dim=axis, keepdim=True)
    v = x.var(dim=axis, keepdim=True, unbiased=False)
    return (x - m) / torch.sqrt(v + eps)
def _scatter_add(tgt, idx, src, axis=0):
    return tgt.clone().index_add_(axis, idx, src)
def _segment_sum(src, seg, n):
    out = torch.zeros((n,) + src.shape[1:], dtype=src.dtype)
    return out.index_add_(0, seg, src)
def _pad(x, pw):
    flat = tuple(v for pair in reversed(pw) for v in pair)
    return torch.nn.functional.pad(x, flat)

kernel_name = 'standalone__mha_softmax__near_ridge'

def setup_inputs():

    _w = (lambda a: (lambda t: t.to(torch.bfloat16) if t.is_floating_point() else t)(torch.as_tensor(a)))
    B, H, Sq, Sk, D = 8, 16, 512, 1024, 256
    return {
        "q": _w((lambda *s: torch.randn(*s, dtype=torch.bfloat16) * 0.8)(B, H, Sq, D)),
        "k": _w((lambda *s: torch.randn(*s, dtype=torch.bfloat16) * 0.8)(B, H, Sk, D)),
        "v": _w((lambda *s: torch.randn(*s, dtype=torch.bfloat16) * 0.05)(B, H, Sk, D)),
    }

def reference(q, k, v):
    scale = q.shape[-1] ** -0.5
    scores = torch.einsum("bhqd,bhkd->bhqk", q, k) * scale
    p = _softmax(scores, axis=-1)
    return torch.einsum("bhqk,bhkd->bhqd", p, v)
```

```asm
; @launch grid=(256,1,1) block=(256,1,1) lds=163840
.amdgcn_target "amdgcn-amd-amdhsa--gfx950"
.text
.globl standalone__mha_softmax__near_ridge_kernel
.p2align 8
.type standalone__mha_softmax__near_ridge_kernel,@function
standalone__mha_softmax__near_ridge_kernel:
    s_cmp_ge_u32 s2, 256
    s_cbranch_scc1 L_end
    s_load_dwordx4 s[36:39], s[0:1], 0
    s_load_dwordx4 s[40:43], s[0:1], 16
    s_and_b32 s44, s2, 7
    s_lshr_b32 s45, s2, 4
    s_lshl_b32 s45, s45, 3
    s_add_u32 s45, s45, s44
    s_bfe_u32 s46, s2, 0x10003
    v_lshrrev_b32 v147, 6, v0
    v_and_b32 v144, 63, v0
    v_readfirstlane_b32 s20, v147
    v_and_b32 v145, 31, v144
    v_lshrrev_b32 v146, 5, v144
    s_lshl_b32 s47, s45, 1
    s_add_u32 s47, s47, s46
    s_lshl_b32 s47, s47, 17
    s_lshl_b32 s45, s45, 19
    s_mov_b32 s21, 0x3db8aa3b
    s_mov_b32 s29, 0x3f803f80
    s_mov_b32 s32, 0x41000000
    s_mov_b32 s26, 16384
    s_mov_b32 s25, 0
    s_mov_b32 s31, 0
    s_mov_b32 s22, 0
    s_mov_b32 s23, 0
    s_lshl_b32 s27, s20, 12
    s_add_u32 s28, s27, 65536
    s_waitcnt lgkmcnt(0)
    s_add_u32 s4, s36, s47
    s_addc_u32 s5, s37, 0
    s_and_b32 s5, s5, 0xffff
    s_mov_b32 s6, 131072
    s_mov_b32 s7, 0x00020000
    s_add_u32 s8, s38, s45
    s_addc_u32 s9, s39, 0
    s_and_b32 s9, s9, 0xffff
    s_mov_b32 s10, 524288
    s_mov_b32 s11, 0x00020000
    s_add_u32 s12, s40, s45
    s_addc_u32 s13, s41, 0
    s_and_b32 s13, s13, 0xffff
    s_mov_b32 s14, 524288
    s_mov_b32 s15, 0x00020000
    s_add_u32 s16, s42, s47
    s_addc_u32 s17, s43, 0
    s_and_b32 s17, s17, 0xffff
    s_mov_b32 s18, 131072
    s_mov_b32 s19, 0x00020000
    v_lshlrev_b32 v148, 9, v146
    v_add_u32 v148, s27, v148
    s_and_b32 s44, s20, 1
    s_lshl_b32 s44, s44, 3
    v_add_u32 v149, s44, v146
    v_add_u32 v147, 0, v149
    v_xor_b32 v147, v147, v145
    v_lshl_add_u32 v236, v147, 4, v148
    v_add_u32 v147, 2, v149
    v_xor_b32 v147, v147, v145
    v_lshl_add_u32 v237, v147, 4, v148
    v_add_u32 v147, 4, v149
    v_xor_b32 v147, v147, v145
    v_lshl_add_u32 v238, v147, 4, v148
    v_add_u32 v147, 6, v149
    v_xor_b32 v147, v147, v145
    v_lshl_add_u32 v239, v147, 4, v148
    s_add_u32 m0, s27, 0
    s_nop 0
    buffer_load_dwordx4 v236, s[8:11], s22 offen offset:0 nt lds
    buffer_load_dwordx4 v237, s[8:11], s22 offen offset:1024 nt lds
    buffer_load_dwordx4 v238, s[8:11], s22 offen offset:2048 nt lds
    buffer_load_dwordx4 v239, s[8:11], s22 offen offset:3072 nt lds
    s_add_u32 s22, s22, 16384
    s_lshl_b32 s44, s20, 15
    v_lshlrev_b32 v150, 9, v146
    v_add_u32 v147, 0, v146
    v_xor_b32 v147, v147, v145
    v_lshl_add_u32 v128, v147, 4, v150
    v_add_u32 v147, 2, v146
    v_xor_b32 v147, v147, v145
    v_lshl_add_u32 v129, v147, 4, v150
    v_add_u32 v147, 4, v146
    v_xor_b32 v147, v147, v145
    v_lshl_add_u32 v130, v147, 4, v150
    v_add_u32 v147, 6, v146
    v_xor_b32 v147, v147, v145
    v_lshl_add_u32 v131, v147, 4, v150
    v_add_u32 v147, 8, v146
    v_xor_b32 v147, v147, v145
    v_lshl_add_u32 v132, v147, 4, v150
    v_add_u32 v147, 10, v146
    v_xor_b32 v147, v147, v145
    v_lshl_add_u32 v133, v147, 4, v150
    v_add_u32 v147, 12, v146
    v_xor_b32 v147, v147, v145
    v_lshl_add_u32 v134, v147, 4, v150
    v_add_u32 v147, 14, v146
    v_xor_b32 v147, v147, v145
    v_lshl_add_u32 v135, v147, 4, v150
    s_lshl_b32 s45, s20, 14
    s_add_u32 s45, s45, 98304
    s_add_u32 m0, s45, 0
    s_add_u32 s47, s44, 0
    buffer_load_dwordx4 v128, s[4:7], s47 offen offset:0 nt lds
    buffer_load_dwordx4 v129, s[4:7], s47 offen offset:1024 nt lds
    buffer_load_dwordx4 v130, s[4:7], s47 offen offset:2048 nt lds
    buffer_load_dwordx4 v131, s[4:7], s47 offen offset:3072 nt lds
    s_add_u32 m0, s45, 4096
    s_add_u32 s47, s44, 4096
    buffer_load_dwordx4 v132, s[4:7], s47 offen offset:0 nt lds
    buffer_load_dwordx4 v133, s[4:7], s47 offen offset:1024 nt lds
    buffer_load_dwordx4 v134, s[4:7], s47 offen offset:2048 nt lds
    buffer_load_dwordx4 v135, s[4:7], s47 offen offset:3072 nt lds
    s_add_u32 m0, s45, 8192
    s_add_u32 s47, s44, 8192
    buffer_load_dwordx4 v128, s[4:7], s47 offen offset:0 nt lds
    buffer_load_dwordx4 v129, s[4:7], s47 offen offset:1024 nt lds
    buffer_load_dwordx4 v130, s[4:7], s47 offen offset:2048 nt lds
    buffer_load_dwordx4 v131, s[4:7], s47 offen offset:3072 nt lds
    s_add_u32 m0, s45, 12288
    s_add_u32 s47, s44, 12288
    buffer_load_dwordx4 v132, s[4:7], s47 offen offset:0 nt lds
    buffer_load_dwordx4 v133, s[4:7], s47 offen offset:1024 nt lds
    buffer_load_dwordx4 v134, s[4:7], s47 offen offset:2048 nt lds
    buffer_load_dwordx4 v135, s[4:7], s47 offen offset:3072 nt lds
    v_add_u32 v147, 0, v146
    v_lshlrev_b32 v147, 1, v147
    v_xor_b32 v147, v147, v145
    v_lshl_add_u32 v240, v147, 4, v148
    v_add_u32 v147, 2, v146
    v_lshlrev_b32 v147, 1, v147
    v_xor_b32 v147, v147, v145
    v_lshl_add_u32 v241, v147, 4, v148
    v_add_u32 v147, 4, v146
    v_lshlrev_b32 v147, 1, v147
    v_xor_b32 v147, v147, v145
    v_lshl_add_u32 v242, v147, 4, v148
    v_add_u32 v147, 6, v146
    v_lshlrev_b32 v147, 1, v147
    v_xor_b32 v147, v147, v145
    v_lshl_add_u32 v243, v147, 4, v148
    v_and_b32 v149, 15, v144
    v_lshrrev_b32 v145, 4, v144
    v_lshlrev_b32 v148, 9, v149
    v_add_u32 v147, 0, v145
    v_xor_b32 v147, v147, v149
    v_lshl_add_u32 v224, v147, 4, v148
    v_add_u32 v147, 4, v145
    v_xor_b32 v147, v147, v149
    v_lshl_add_u32 v225, v147, 4, v148
    v_add_u32 v147, 8, v145
    v_xor_b32 v147, v147, v149
    v_lshl_add_u32 v226, v147, 4, v148
    v_add_u32 v147, 12, v145
    v_xor_b32 v147, v147, v149
    v_lshl_add_u32 v227, v147, 4, v148
    v_bfe_u32 v149, v144, 2, 2
    v_lshl_add_u32 v148, v145, 2, v149
    v_and_b32 v149, 7, v148
    v_lshlrev_b32 v148, 9, v148
    v_add_u32 v148, 0x10000, v148
    v_and_b32 v147, 3, v144
    v_lshl_add_u32 v148, v147, 3, v148
    v_xor_b32 v147, 0, v149
    v_lshl_add_u32 v228, v147, 5, v148
    v_xor_b32 v147, 1, v149
    v_lshl_add_u32 v229, v147, 5, v148
    v_xor_b32 v147, 2, v149
    v_lshl_add_u32 v230, v147, 5, v148
    v_xor_b32 v147, 3, v149
    v_lshl_add_u32 v231, v147, 5, v148
    v_xor_b32 v147, 4, v149
    v_lshl_add_u32 v232, v147, 5, v148
    v_xor_b32 v147, 5, v149
    v_lshl_add_u32 v233, v147, 5, v148
    v_xor_b32 v147, 6, v149
    v_lshl_add_u32 v234, v147, 5, v148
    v_xor_b32 v147, 7, v149
    v_lshl_add_u32 v235, v147, 5, v148
    v_mov_b32 v208, 0
    v_mov_b32 v209, 0
    v_mov_b32 v210, 0
    v_mov_b32 v211, 0
    v_mov_b32 v244, 0
    v_mov_b32 v248, 1.0
    v_mov_b32 v212, 0
    v_mov_b32 v213, 0
    v_mov_b32 v214, 0
    v_mov_b32 v215, 0
    v_mov_b32 v245, 0
    v_mov_b32 v249, 1.0
    v_mov_b32 v216, 0
    v_mov_b32 v217, 0
    v_mov_b32 v218, 0
    v_mov_b32 v219, 0
    v_mov_b32 v246, 0
    v_mov_b32 v250, 1.0
    v_mov_b32 v220, 0
    v_mov_b32 v221, 0
    v_mov_b32 v222, 0
    v_mov_b32 v223, 0
    v_mov_b32 v247, 0
    v_mov_b32 v251, 1.0
    s_mov_b32 s31, 0xff800000
    s_mov_b32 s33, 0xffff0000
    s_mov_b32 s34, 0x3db8aa3b
    s_mov_b32 s35, 0x3db8aa3b
    v_mov_b32 v0, 0
    v_mov_b32 v1, 0
    v_mov_b32 v2, 0
    v_mov_b32 v3, 0
    v_mov_b32 v4, 0
    v_mov_b32 v5, 0
    v_mov_b32 v6, 0
    v_mov_b32 v7, 0
    v_mov_b32 v8, 0
    v_mov_b32 v9, 0
    v_mov_b32 v10, 0
    v_mov_b32 v11, 0
    v_mov_b32 v12, 0
    v_mov_b32 v13, 0
    v_mov_b32 v14, 0
    v_mov_b32 v15, 0
    v_mov_b32 v16, 0
    v_mov_b32 v17, 0
    v_mov_b32 v18, 0
    v_mov_b32 v19, 0
    v_mov_b32 v20, 0
    v_mov_b32 v21, 0
    v_mov_b32 v22, 0
    v_mov_b32 v23, 0
    v_mov_b32 v24, 0
    v_mov_b32 v25, 0
    v_mov_b32 v26, 0
    v_mov_b32 v27, 0
    v_mov_b32 v28, 0
    v_mov_b32 v29, 0
    v_mov_b32 v30, 0
    v_mov_b32 v31, 0
    v_mov_b32 v32, 0
    v_mov_b32 v33, 0
    v_mov_b32 v34, 0
    v_mov_b32 v35, 0
    v_mov_b32 v36, 0
    v_mov_b32 v37, 0
    v_mov_b32 v38, 0
    v_mov_b32 v39, 0
    v_mov_b32 v40, 0
    v_mov_b32 v41, 0
    v_mov_b32 v42, 0
    v_mov_b32 v43, 0
    v_mov_b32 v44, 0
    v_mov_b32 v45, 0
    v_mov_b32 v46, 0
    v_mov_b32 v47, 0
    v_mov_b32 v48, 0
    v_mov_b32 v49, 0
    v_mov_b32 v50, 0
    v_mov_b32 v51, 0
    v_mov_b32 v52, 0
    v_mov_b32 v53, 0
    v_mov_b32 v54, 0
    v_mov_b32 v55, 0
    v_mov_b32 v56, 0
    v_mov_b32 v57, 0
    v_mov_b32 v58, 0
    v_mov_b32 v59, 0
    v_mov_b32 v60, 0
    v_mov_b32 v61, 0
    v_mov_b32 v62, 0
    v_mov_b32 v63, 0
    v_mov_b32 v64, 0
    v_mov_b32 v65, 0
    v_mov_b32 v66, 0
    v_mov_b32 v67, 0
    v_mov_b32 v68, 0
    v_mov_b32 v69, 0
    v_mov_b32 v70, 0
    v_mov_b32 v71, 0
    v_mov_b32 v72, 0
    v_mov_b32 v73, 0
    v_mov_b32 v74, 0
    v_mov_b32 v75, 0
    v_mov_b32 v76, 0
    v_mov_b32 v77, 0
    v_mov_b32 v78, 0
    v_mov_b32 v79, 0
    v_mov_b32 v80, 0
    v_mov_b32 v81, 0
    v_mov_b32 v82, 0
    v_mov_b32 v83, 0
    v_mov_b32 v84, 0
    v_mov_b32 v85, 0
    v_mov_b32 v86, 0
    v_mov_b32 v87, 0
    v_mov_b32 v88, 0
    v_mov_b32 v89, 0
    v_mov_b32 v90, 0
    v_mov_b32 v91, 0
    v_mov_b32 v92, 0
    v_mov_b32 v93, 0
    v_mov_b32 v94, 0
    v_mov_b32 v95, 0
    v_mov_b32 v96, 0
    v_mov_b32 v97, 0
    v_mov_b32 v98, 0
    v_mov_b32 v99, 0
    v_mov_b32 v100, 0
    v_mov_b32 v101, 0
    v_mov_b32 v102, 0
    v_mov_b32 v103, 0
    v_mov_b32 v104, 0
    v_mov_b32 v105, 0
    v_mov_b32 v106, 0
    v_mov_b32 v107, 0
    v_mov_b32 v108, 0
    v_mov_b32 v109, 0
    v_mov_b32 v110, 0
    v_mov_b32 v111, 0
    v_mov_b32 v112, 0
    v_mov_b32 v113, 0
    v_mov_b32 v114, 0
    v_mov_b32 v115, 0
    v_mov_b32 v116, 0
    v_mov_b32 v117, 0
    v_mov_b32 v118, 0
    v_mov_b32 v119, 0
    v_mov_b32 v120, 0
    v_mov_b32 v121, 0
    v_mov_b32 v122, 0
    v_mov_b32 v123, 0
    v_mov_b32 v124, 0
    v_mov_b32 v125, 0
    v_mov_b32 v126, 0
    v_mov_b32 v127, 0
    v_accvgpr_write_b32 a0, 0
    v_accvgpr_write_b32 a1, 0
    v_accvgpr_write_b32 a2, 0
    v_accvgpr_write_b32 a3, 0
    v_accvgpr_write_b32 a4, 0
    v_accvgpr_write_b32 a5, 0
    v_accvgpr_write_b32 a6, 0
    v_accvgpr_write_b32 a7, 0
    v_accvgpr_write_b32 a8, 0
    v_accvgpr_write_b32 a9, 0
    v_accvgpr_write_b32 a10, 0
    v_accvgpr_write_b32 a11, 0
    v_accvgpr_write_b32 a12, 0
    v_accvgpr_write_b32 a13, 0
    v_accvgpr_write_b32 a14, 0
    v_accvgpr_write_b32 a15, 0
    v_accvgpr_write_b32 a16, 0
    v_accvgpr_write_b32 a17, 0
    v_accvgpr_write_b32 a18, 0
    v_accvgpr_write_b32 a19, 0
    v_accvgpr_write_b32 a20, 0
    v_accvgpr_write_b32 a21, 0
    v_accvgpr_write_b32 a22, 0
    v_accvgpr_write_b32 a23, 0
    v_accvgpr_write_b32 a24, 0
    v_accvgpr_write_b32 a25, 0
    v_accvgpr_write_b32 a26, 0
    v_accvgpr_write_b32 a27, 0
    v_accvgpr_write_b32 a28, 0
    v_accvgpr_write_b32 a29, 0
    v_accvgpr_write_b32 a30, 0
    v_accvgpr_write_b32 a31, 0
    v_accvgpr_write_b32 a32, 0
    v_accvgpr_write_b32 a33, 0
    v_accvgpr_write_b32 a34, 0
    v_accvgpr_write_b32 a35, 0
    v_accvgpr_write_b32 a36, 0
    v_accvgpr_write_b32 a37, 0
    v_accvgpr_write_b32 a38, 0
    v_accvgpr_write_b32 a39, 0
    v_accvgpr_write_b32 a40, 0
    v_accvgpr_write_b32 a41, 0
    v_accvgpr_write_b32 a42, 0
    v_accvgpr_write_b32 a43, 0
    v_accvgpr_write_b32 a44, 0
    v_accvgpr_write_b32 a45, 0
    v_accvgpr_write_b32 a46, 0
    v_accvgpr_write_b32 a47, 0
    v_accvgpr_write_b32 a48, 0
    v_accvgpr_write_b32 a49, 0
    v_accvgpr_write_b32 a50, 0
    v_accvgpr_write_b32 a51, 0
    v_accvgpr_write_b32 a52, 0
    v_accvgpr_write_b32 a53, 0
    v_accvgpr_write_b32 a54, 0
    v_accvgpr_write_b32 a55, 0
    v_accvgpr_write_b32 a56, 0
    v_accvgpr_write_b32 a57, 0
    v_accvgpr_write_b32 a58, 0
    v_accvgpr_write_b32 a59, 0
    v_accvgpr_write_b32 a60, 0
    v_accvgpr_write_b32 a61, 0
    v_accvgpr_write_b32 a62, 0
    v_accvgpr_write_b32 a63, 0
    v_accvgpr_write_b32 a64, 0
    v_accvgpr_write_b32 a65, 0
    v_accvgpr_write_b32 a66, 0
    v_accvgpr_write_b32 a67, 0
    v_accvgpr_write_b32 a68, 0
    v_accvgpr_write_b32 a69, 0
    v_accvgpr_write_b32 a70, 0
    v_accvgpr_write_b32 a71, 0
    v_accvgpr_write_b32 a72, 0
    v_accvgpr_write_b32 a73, 0
    v_accvgpr_write_b32 a74, 0
    v_accvgpr_write_b32 a75, 0
    v_accvgpr_write_b32 a76, 0
    v_accvgpr_write_b32 a77, 0
    v_accvgpr_write_b32 a78, 0
    v_accvgpr_write_b32 a79, 0
    v_accvgpr_write_b32 a80, 0
    v_accvgpr_write_b32 a81, 0
    v_accvgpr_write_b32 a82, 0
    v_accvgpr_write_b32 a83, 0
    v_accvgpr_write_b32 a84, 0
    v_accvgpr_write_b32 a85, 0
    v_accvgpr_write_b32 a86, 0
    v_accvgpr_write_b32 a87, 0
    v_accvgpr_write_b32 a88, 0
    v_accvgpr_write_b32 a89, 0
    v_accvgpr_write_b32 a90, 0
    v_accvgpr_write_b32 a91, 0
    v_accvgpr_write_b32 a92, 0
    v_accvgpr_write_b32 a93, 0
    v_accvgpr_write_b32 a94, 0
    v_accvgpr_write_b32 a95, 0
    v_accvgpr_write_b32 a96, 0
    v_accvgpr_write_b32 a97, 0
    v_accvgpr_write_b32 a98, 0
    v_accvgpr_write_b32 a99, 0
    v_accvgpr_write_b32 a100, 0
    v_accvgpr_write_b32 a101, 0
    v_accvgpr_write_b32 a102, 0
    v_accvgpr_write_b32 a103, 0
    v_accvgpr_write_b32 a104, 0
    v_accvgpr_write_b32 a105, 0
    v_accvgpr_write_b32 a106, 0
    v_accvgpr_write_b32 a107, 0
    v_accvgpr_write_b32 a108, 0
    v_accvgpr_write_b32 a109, 0
    v_accvgpr_write_b32 a110, 0
    v_accvgpr_write_b32 a111, 0
    v_accvgpr_write_b32 a112, 0
    v_accvgpr_write_b32 a113, 0
    v_accvgpr_write_b32 a114, 0
    v_accvgpr_write_b32 a115, 0
    v_accvgpr_write_b32 a116, 0
    v_accvgpr_write_b32 a117, 0
    v_accvgpr_write_b32 a118, 0
    v_accvgpr_write_b32 a119, 0
    v_accvgpr_write_b32 a120, 0
    v_accvgpr_write_b32 a121, 0
    v_accvgpr_write_b32 a122, 0
    v_accvgpr_write_b32 a123, 0
    v_accvgpr_write_b32 a124, 0
    v_accvgpr_write_b32 a125, 0
    v_accvgpr_write_b32 a126, 0
    v_accvgpr_write_b32 a127, 0
    v_add_u32 v136, s45, v224
    v_add_u32 v137, s45, v225
    v_add_u32 v138, s45, v226
    v_add_u32 v139, s45, v227
    s_waitcnt vmcnt(8)
    ds_read_b128 v[160:163], v136 offset:0
    ds_read_b128 v[164:167], v137 offset:0
    ds_read_b128 v[168:171], v138 offset:0
    ds_read_b128 v[172:175], v139 offset:0
    ds_read_b128 v[176:179], v136 offset:256
    ds_read_b128 v[180:183], v137 offset:256
    ds_read_b128 v[184:187], v138 offset:256
    ds_read_b128 v[188:191], v139 offset:256
    s_waitcnt lgkmcnt(0)
    s_add_u32 m0, s45, 0
    s_add_u32 s47, s44, 16384
    buffer_load_dwordx4 v128, s[4:7], s47 offen offset:0 nt lds
    buffer_load_dwordx4 v129, s[4:7], s47 offen offset:1024 nt lds
    buffer_load_dwordx4 v130, s[4:7], s47 offen offset:2048 nt lds
    buffer_load_dwordx4 v131, s[4:7], s47 offen offset:3072 nt lds
    s_add_u32 m0, s45, 4096
    s_add_u32 s47, s44, 20480
    buffer_load_dwordx4 v132, s[4:7], s47 offen offset:0 nt lds
    buffer_load_dwordx4 v133, s[4:7], s47 offen offset:1024 nt lds
    buffer_load_dwordx4 v134, s[4:7], s47 offen offset:2048 nt lds
    buffer_load_dwordx4 v135, s[4:7], s47 offen offset:3072 nt lds
    v_lshlrev_b32 v252, 16, v160
    v_and_b32 v253, s33, v160
    v_lshlrev_b32 v254, 16, v161
    v_and_b32 v255, s33, v161
    v_pk_mul_f32 v[252:253], v[252:253], s[34:35]
    v_pk_mul_f32 v[254:255], v[254:255], s[34:35]
    v_cvt_pk_bf16_f32 v160, v252, v253
    v_cvt_pk_bf16_f32 v161, v254, v255
    v_accvgpr_write_b32 a128, v160
    v_accvgpr_write_b32 a129, v161
    v_lshlrev_b32 v252, 16, v162
    v_and_b32 v253, s33, v162
    v_lshlrev_b32 v254, 16, v163
    v_and_b32 v255, s33, v163
    v_pk_mul_f32 v[252:253], v[252:253], s[34:35]
    v_pk_mul_f32 v[254:255], v[254:255], s[34:35]
    v_cvt_pk_bf16_f32 v162, v252, v253
    v_cvt_pk_bf16_f32 v163, v254, v255
    v_accvgpr_write_b32 a130, v162
    v_accvgpr_write_b32 a131, v163
    v_lshlrev_b32 v252, 16, v164
    v_and_b32 v253, s33, v164
    v_lshlrev_b32 v254, 16, v165
    v_and_b32 v255, s33, v165
    v_pk_mul_f32 v[252:253], v[252:253], s[34:35]
    v_pk_mul_f32 v[254:255], v[254:255], s[34:35]
    v_cvt_pk_bf16_f32 v164, v252, v253
    v_cvt_pk_bf16_f32 v165, v254, v255
    v_accvgpr_write_b32 a132, v164
    v_accvgpr_write_b32 a133, v165
    v_lshlrev_b32 v252, 16, v166
    v_and_b32 v253, s33, v166
    v_lshlrev_b32 v254, 16, v167
    v_and_b32 v255, s33, v167
    v_pk_mul_f32 v[252:253], v[252:253], s[34:35]
    v_pk_mul_f32 v[254:255], v[254:255], s[34:35]
    v_cvt_pk_bf16_f32 v166, v252, v253
    v_cvt_pk_bf16_f32 v167, v254, v255
    v_accvgpr_write_b32 a134, v166
    v_accvgpr_write_b32 a135, v167
    v_lshlrev_b32 v252, 16, v168
    v_and_b32 v253, s33, v168
    v_lshlrev_b32 v254, 16, v169
    v_and_b32 v255, s33, v169
    v_pk_mul_f32 v[252:253], v[252:253], s[34:35]
    v_pk_mul_f32 v[254:255], v[254:255], s[34:35]
    v_cvt_pk_bf16_f32 v168, v252, v253
    v_cvt_pk_bf16_f32 v169, v254, v255
    v_accvgpr_write_b32 a136, v168
    v_accvgpr_write_b32 a137, v169
    v_lshlrev_b32 v252, 16, v170
    v_and_b32 v253, s33, v170
    v_lshlrev_b32 v254, 16, v171
    v_and_b32 v255, s33, v171
    v_pk_mul_f32 v[252:253], v[252:253], s[34:35]
    v_pk_mul_f32 v[254:255], v[254:255], s[34:35]
    v_cvt_pk_bf16_f32 v170, v252, v253
    v_cvt_pk_bf16_f32 v171, v254, v255
    v_accvgpr_write_b32 a138, v170
    v_accvgpr_write_b32 a139, v171
    v_lshlrev_b32 v252, 16, v172
    v_and_b32 v253, s33, v172
    v_lshlrev_b32 v254, 16, v173
    v_and_b32 v255, s33, v173
    v_pk_mul_f32 v[252:253], v[252:253], s[34:35]
    v_pk_mul_f32 v[254:255], v[254:255], s[34:35]
    v_cvt_pk_bf16_f32 v172, v252, v253
    v_cvt_pk_bf16_f32 v173, v254, v255
    v_accvgpr_write_b32 a140, v172
    v_accvgpr_write_b32 a141, v173
    v_lshlrev_b32 v252, 16, v174
    v_and_b32 v253, s33, v174
    v_lshlrev_b32 v254, 16, v175
    v_and_b32 v255, s33, v175
    v_pk_mul_f32 v[252:253], v[252:253], s[34:35]
    v_pk_mul_f32 v[254:255], v[254:255], s[34:35]
    v_cvt_pk_bf16_f32 v174, v252, v253
    v_cvt_pk_bf16_f32 v175, v254, v255
    v_accvgpr_write_b32 a142, v174
    v_accvgpr_write_b32 a143, v175
    v_lshlrev_b32 v252, 16, v176
    v_and_b32 v253, s33, v176
    v_lshlrev_b32 v254, 16, v177
    v_and_b32 v255, s33, v177
    v_pk_mul_f32 v[252:253], v[252:253], s[34:35]
    v_pk_mul_f32 v[254:255], v[254:255], s[34:35]
    v_cvt_pk_bf16_f32 v176, v252, v253
    v_cvt_pk_bf16_f32 v177, v254, v255
    v_accvgpr_write_b32 a144, v176
    v_accvgpr_write_b32 a145, v177
    v_lshlrev_b32 v252, 16, v178
    v_and_b32 v253, s33, v178
    v_lshlrev_b32 v254, 16, v179
    v_and_b32 v255, s33, v179
    v_pk_mul_f32 v[252:253], v[252:253], s[34:35]
    v_pk_mul_f32 v[254:255], v[254:255], s[34:35]
    v_cvt_pk_bf16_f32 v178, v252, v253
    v_cvt_pk_bf16_f32 v179, v254, v255
    v_accvgpr_write_b32 a146, v178
    v_accvgpr_write_b32 a147, v179
    v_lshlrev_b32 v252, 16, v180
    v_and_b32 v253, s33, v180
    v_lshlrev_b32 v254, 16, v181
    v_and_b32 v255, s33, v181
    v_pk_mul_f32 v[252:253], v[252:253], s[34:35]
    v_pk_mul_f32 v[254:255], v[254:255], s[34:35]
    v_cvt_pk_bf16_f32 v180, v252, v253
    v_cvt_pk_bf16_f32 v181, v254, v255
    v_accvgpr_write_b32 a148, v180
    v_accvgpr_write_b32 a149, v181
    v_lshlrev_b32 v252, 16, v182
    v_and_b32 v253, s33, v182
    v_lshlrev_b32 v254, 16, v183
    v_and_b32 v255, s33, v183
    v_pk_mul_f32 v[252:253], v[252:253], s[34:35]
    v_pk_mul_f32 v[254:255], v[254:255], s[34:35]
    v_cvt_pk_bf16_f32 v182, v252, v253
    v_cvt_pk_bf16_f32 v183, v254, v255
    v_accvgpr_write_b32 a150, v182
    v_accvgpr_write_b32 a151, v183
    v_lshlrev_b32 v252, 16, v184
    v_and_b32 v253, s33, v184
    v_lshlrev_b32 v254, 16, v185
    v_and_b32 v255, s33, v185
    v_pk_mul_f32 v[252:253], v[252:253], s[34:35]
    v_pk_mul_f32 v[254:255], v[254:255], s[34:35]
    v_cvt_pk_bf16_f32 v184, v252, v253
    v_cvt_pk_bf16_f32 v185, v254, v255
    v_accvgpr_write_b32 a152, v184
    v_accvgpr_write_b32 a153, v185
    v_lshlrev_b32 v252, 16, v186
    v_and_b32 v253, s33, v186
    v_lshlrev_b32 v254, 16, v187
    v_and_b32 v255, s33, v187
    v_pk_mul_f32 v[252:253], v[252:253], s[34:35]
    v_pk_mul_f32 v[254:255], v[254:255], s[34:35]
    v_cvt_pk_bf16_f32 v186, v252, v253
    v_cvt_pk_bf16_f32 v187, v254, v255
    v_accvgpr_write_b32 a154, v186
    v_accvgpr_write_b32 a155, v187
    v_lshlrev_b32 v252, 16, v188
    v_and_b32 v253, s33, v188
    v_lshlrev_b32 v254, 16, v189
    v_and_b32 v255, s33, v189
    v_pk_mul_f32 v[252:253], v[252:253], s[34:35]
    v_pk_mul_f32 v[254:255], v[254:255], s[34:35]
    v_cvt_pk_bf16_f32 v188, v252, v253
    v_cvt_pk_bf16_f32 v189, v254, v255
    v_accvgpr_write_b32 a156, v188
    v_accvgpr_write_b32 a157, v189
    v_lshlrev_b32 v252, 16, v190
    v_and_b32 v253, s33, v190
    v_lshlrev_b32 v254, 16, v191
    v_and_b32 v255, s33, v191
    v_pk_mul_f32 v[252:253], v[252:253], s[34:35]
    v_pk_mul_f32 v[254:255], v[254:255], s[34:35]
    v_cvt_pk_bf16_f32 v190, v252, v253
    v_cvt_pk_bf16_f32 v191, v254, v255
    v_accvgpr_write_b32 a158, v190
    v_accvgpr_write_b32 a159, v191
    s_waitcnt vmcnt(8)
    ds_read_b128 v[160:163], v136 offset:8192
    ds_read_b128 v[164:167], v137 offset:8192
    ds_read_b128 v[168:171], v138 offset:8192
    ds_read_b128 v[172:175], v139 offset:8192
    ds_read_b128 v[176:179], v136 offset:8448
    ds_read_b128 v[180:183], v137 offset:8448
    ds_read_b128 v[184:187], v138 offset:8448
    ds_read_b128 v[188:191], v139 offset:8448
    s_waitcnt lgkmcnt(0)
    s_add_u32 m0, s45, 8192
    s_add_u32 s47, s44, 24576
    buffer_load_dwordx4 v128, s[4:7], s47 offen offset:0 nt lds
    buffer_load_dwordx4 v129, s[4:7], s47 offen offset:1024 nt lds
    buffer_load_dwordx4 v130, s[4:7], s47 offen offset:2048 nt lds
    buffer_load_dwordx4 v131, s[4:7], s47 offen offset:3072 nt lds
    s_add_u32 m0, s45, 12288
    s_add_u32 s47, s44, 28672
    buffer_load_dwordx4 v132, s[4:7], s47 offen offset:0 nt lds
    buffer_load_dwordx4 v133, s[4:7], s47 offen offset:1024 nt lds
    buffer_load_dwordx4 v134, s[4:7], s47 offen offset:2048 nt lds
    buffer_load_dwordx4 v135, s[4:7], s47 offen offset:3072 nt lds
    s_add_u32 m0, s27, 16384
    s_nop 0
    buffer_load_dwordx4 v236, s[8:11], s22 offen offset:0 nt lds
    buffer_load_dwordx4 v237, s[8:11], s22 offen offset:1024 nt lds
    buffer_load_dwordx4 v238, s[8:11], s22 offen offset:2048 nt lds
    buffer_load_dwordx4 v239, s[8:11], s22 offen offset:3072 nt lds
    s_add_u32 s22, s22, 16384
    v_lshlrev_b32 v252, 16, v160
    v_and_b32 v253, s33, v160
    v_lshlrev_b32 v254, 16, v161
    v_and_b32 v255, s33, v161
    v_pk_mul_f32 v[252:253], v[252:253], s[34:35]
    v_pk_mul_f32 v[254:255], v[254:255], s[34:35]
    v_cvt_pk_bf16_f32 v160, v252, v253
    v_cvt_pk_bf16_f32 v161, v254, v255
    v_accvgpr_write_b32 a160, v160
    v_accvgpr_write_b32 a161, v161
    v_lshlrev_b32 v252, 16, v162
    v_and_b32 v253, s33, v162
    v_lshlrev_b32 v254, 16, v163
    v_and_b32 v255, s33, v163
    v_pk_mul_f32 v[252:253], v[252:253], s[34:35]
    v_pk_mul_f32 v[254:255], v[254:255], s[34:35]
    v_cvt_pk_bf16_f32 v162, v252, v253
    v_cvt_pk_bf16_f32 v163, v254, v255
    v_accvgpr_write_b32 a162, v162
    v_accvgpr_write_b32 a163, v163
    v_lshlrev_b32 v252, 16, v164
    v_and_b32 v253, s33, v164
    v_lshlrev_b32 v254, 16, v165
    v_and_b32 v255, s33, v165
    v_pk_mul_f32 v[252:253], v[252:253], s[34:35]
    v_pk_mul_f32 v[254:255], v[254:255], s[34:35]
    v_cvt_pk_bf16_f32 v164, v252, v253
    v_cvt_pk_bf16_f32 v165, v254, v255
    v_accvgpr_write_b32 a164, v164
    v_accvgpr_write_b32 a165, v165
    v_lshlrev_b32 v252, 16, v166
    v_and_b32 v253, s33, v166
    v_lshlrev_b32 v254, 16, v167
    v_and_b32 v255, s33, v167
    v_pk_mul_f32 v[252:253], v[252:253], s[34:35]
    v_pk_mul_f32 v[254:255], v[254:255], s[34:35]
    v_cvt_pk_bf16_f32 v166, v252, v253
    v_cvt_pk_bf16_f32 v167, v254, v255
    v_accvgpr_write_b32 a166, v166
    v_accvgpr_write_b32 a167, v167
    v_lshlrev_b32 v252, 16, v168
    v_and_b32 v253, s33, v168
    v_lshlrev_b32 v254, 16, v169
    v_and_b32 v255, s33, v169
    v_pk_mul_f32 v[252:253], v[252:253], s[34:35]
    v_pk_mul_f32 v[254:255], v[254:255], s[34:35]
    v_cvt_pk_bf16_f32 v168, v252, v253
    v_cvt_pk_bf16_f32 v169, v254, v255
    v_accvgpr_write_b32 a168, v168
    v_accvgpr_write_b32 a169, v169
    v_lshlrev_b32 v252, 16, v170
    v_and_b32 v253, s33, v170
    v_lshlrev_b32 v254, 16, v171
    v_and_b32 v255, s33, v171
    v_pk_mul_f32 v[252:253], v[252:253], s[34:35]
    v_pk_mul_f32 v[254:255], v[254:255], s[34:35]
    v_cvt_pk_bf16_f32 v170, v252, v253
    v_cvt_pk_bf16_f32 v171, v254, v255
    v_accvgpr_write_b32 a170, v170
    v_accvgpr_write_b32 a171, v171
    v_lshlrev_b32 v252, 16, v172
    v_and_b32 v253, s33, v172
    v_lshlrev_b32 v254, 16, v173
    v_and_b32 v255, s33, v173
    v_pk_mul_f32 v[252:253], v[252:253], s[34:35]
    v_pk_mul_f32 v[254:255], v[254:255], s[34:35]
    v_cvt_pk_bf16_f32 v172, v252, v253
    v_cvt_pk_bf16_f32 v173, v254, v255
    v_accvgpr_write_b32 a172, v172
    v_accvgpr_write_b32 a173, v173
    v_lshlrev_b32 v252, 16, v174
    v_and_b32 v253, s33, v174
    v_lshlrev_b32 v254, 16, v175
    v_and_b32 v255, s33, v175
    v_pk_mul_f32 v[252:253], v[252:253], s[34:35]
    v_pk_mul_f32 v[254:255], v[254:255], s[34:35]
    v_cvt_pk_bf16_f32 v174, v252, v253
    v_cvt_pk_bf16_f32 v175, v254, v255
    v_accvgpr_write_b32 a174, v174
    v_accvgpr_write_b32 a175, v175
    v_lshlrev_b32 v252, 16, v176
    v_and_b32 v253, s33, v176
    v_lshlrev_b32 v254, 16, v177
    v_and_b32 v255, s33, v177
    v_pk_mul_f32 v[252:253], v[252:253], s[34:35]
    v_pk_mul_f32 v[254:255], v[254:255], s[34:35]
    v_cvt_pk_bf16_f32 v176, v252, v253
    v_cvt_pk_bf16_f32 v177, v254, v255
    v_accvgpr_write_b32 a176, v176
    v_accvgpr_write_b32 a177, v177
    v_lshlrev_b32 v252, 16, v178
    v_and_b32 v253, s33, v178
    v_lshlrev_b32 v254, 16, v179
    v_and_b32 v255, s33, v179
    v_pk_mul_f32 v[252:253], v[252:253], s[34:35]
    v_pk_mul_f32 v[254:255], v[254:255], s[34:35]
    v_cvt_pk_bf16_f32 v178, v252, v253
    v_cvt_pk_bf16_f32 v179, v254, v255
    v_accvgpr_write_b32 a178, v178
    v_accvgpr_write_b32 a179, v179
    v_lshlrev_b32 v252, 16, v180
    v_and_b32 v253, s33, v180
    v_lshlrev_b32 v254, 16, v181
    v_and_b32 v255, s33, v181
    v_pk_mul_f32 v[252:253], v[252:253], s[34:35]
    v_pk_mul_f32 v[254:255], v[254:255], s[34:35]
    v_cvt_pk_bf16_f32 v180, v252, v253
    v_cvt_pk_bf16_f32 v181, v254, v255
    v_accvgpr_write_b32 a180, v180
    v_accvgpr_write_b32 a181, v181
    v_lshlrev_b32 v252, 16, v182
    v_and_b32 v253, s33, v182
    v_lshlrev_b32 v254, 16, v183
    v_and_b32 v255, s33, v183
    v_pk_mul_f32 v[252:253], v[252:253], s[34:35]
    v_pk_mul_f32 v[254:255], v[254:255], s[34:35]
    v_cvt_pk_bf16_f32 v182, v252, v253
    v_cvt_pk_bf16_f32 v183, v254, v255
    v_accvgpr_write_b32 a182, v182
    v_accvgpr_write_b32 a183, v183
    v_lshlrev_b32 v252, 16, v184
    v_and_b32 v253, s33, v184
    v_lshlrev_b32 v254, 16, v185
    v_and_b32 v255, s33, v185
    v_pk_mul_f32 v[252:253], v[252:253], s[34:35]
    v_pk_mul_f32 v[254:255], v[254:255], s[34:35]
    v_cvt_pk_bf16_f32 v184, v252, v253
    v_cvt_pk_bf16_f32 v185, v254, v255
    v_accvgpr_write_b32 a184, v184
    v_accvgpr_write_b32 a185, v185
    v_lshlrev_b32 v252, 16, v186
    v_and_b32 v253, s33, v186
    v_lshlrev_b32 v254, 16, v187
    v_and_b32 v255, s33, v187
    v_pk_mul_f32 v[252:253], v[252:253], s[34:35]
    v_pk_mul_f32 v[254:255], v[254:255], s[34:35]
    v_cvt_pk_bf16_f32 v186, v252, v253
    v_cvt_pk_bf16_f32 v187, v254, v255
    v_accvgpr_write_b32 a186, v186
    v_accvgpr_write_b32 a187, v187
    v_lshlrev_b32 v252, 16, v188
    v_and_b32 v253, s33, v188
    v_lshlrev_b32 v254, 16, v189
    v_and_b32 v255, s33, v189
    v_pk_mul_f32 v[252:253], v[252:253], s[34:35]
    v_pk_mul_f32 v[254:255], v[254:255], s[34:35]
    v_cvt_pk_bf16_f32 v188, v252, v253
    v_cvt_pk_bf16_f32 v189, v254, v255
    v_accvgpr_write_b32 a188, v188
    v_accvgpr_write_b32 a189, v189
    v_lshlrev_b32 v252, 16, v190
    v_and_b32 v253, s33, v190
    v_lshlrev_b32 v254, 16, v191
    v_and_b32 v255, s33, v191
    v_pk_mul_f32 v[252:253], v[252:253], s[34:35]
    v_pk_mul_f32 v[254:255], v[254:255], s[34:35]
    v_cvt_pk_bf16_f32 v190, v252, v253
    v_cvt_pk_bf16_f32 v191, v254, v255
    v_accvgpr_write_b32 a190, v190
    v_accvgpr_write_b32 a191, v191
    s_waitcnt vmcnt(12)
    ds_read_b128 v[160:163], v136 offset:0
    ds_read_b128 v[164:167], v137 offset:0
    ds_read_b128 v[168:171], v138 offset:0
    ds_read_b128 v[172:175], v139 offset:0
    ds_read_b128 v[176:179], v136 offset:256
    ds_read_b128 v[180:183], v137 offset:256
    ds_read_b128 v[184:187], v138 offset:256
    ds_read_b128 v[188:191], v139 offset:256
    s_waitcnt lgkmcnt(7)
    v_lshlrev_b32 v252, 16, v160
    v_and_b32 v253, s33, v160
    v_lshlrev_b32 v254, 16, v161
    v_and_b32 v255, s33, v161
    v_pk_mul_f32 v[252:253], v[252:253], s[34:35]
    v_pk_mul_f32 v[254:255], v[254:255], s[34:35]
    v_cvt_pk_bf16_f32 v160, v252, v253
    v_cvt_pk_bf16_f32 v161, v254, v255
    v_accvgpr_write_b32 a192, v160
    v_accvgpr_write_b32 a193, v161
    v_lshlrev_b32 v252, 16, v162
    v_and_b32 v253, s33, v162
    v_lshlrev_b32 v254, 16, v163
    v_and_b32 v255, s33, v163
    v_pk_mul_f32 v[252:253], v[252:253], s[34:35]
    v_pk_mul_f32 v[254:255], v[254:255], s[34:35]
    v_cvt_pk_bf16_f32 v162, v252, v253
    v_cvt_pk_bf16_f32 v163, v254, v255
    v_accvgpr_write_b32 a194, v162
    v_accvgpr_write_b32 a195, v163
    s_waitcnt lgkmcnt(6)
    v_lshlrev_b32 v252, 16, v164
    v_and_b32 v253, s33, v164
    v_lshlrev_b32 v254, 16, v165
    v_and_b32 v255, s33, v165
    v_pk_mul_f32 v[252:253], v[252:253], s[34:35]
    v_pk_mul_f32 v[254:255], v[254:255], s[34:35]
    v_cvt_pk_bf16_f32 v164, v252, v253
    v_cvt_pk_bf16_f32 v165, v254, v255
    v_accvgpr_write_b32 a196, v164
    v_accvgpr_write_b32 a197, v165
    v_lshlrev_b32 v252, 16, v166
    v_and_b32 v253, s33, v166
    v_lshlrev_b32 v254, 16, v167
    v_and_b32 v255, s33, v167
    v_pk_mul_f32 v[252:253], v[252:253], s[34:35]
    v_pk_mul_f32 v[254:255], v[254:255], s[34:35]
    v_cvt_pk_bf16_f32 v166, v252, v253
    v_cvt_pk_bf16_f32 v167, v254, v255
    v_accvgpr_write_b32 a198, v166
    v_accvgpr_write_b32 a199, v167
    s_waitcnt lgkmcnt(5)
    v_lshlrev_b32 v252, 16, v168
    v_and_b32 v253, s33, v168
    v_lshlrev_b32 v254, 16, v169
    v_and_b32 v255, s33, v169
    v_pk_mul_f32 v[252:253], v[252:253], s[34:35]
    v_pk_mul_f32 v[254:255], v[254:255], s[34:35]
    v_cvt_pk_bf16_f32 v168, v252, v253
    v_cvt_pk_bf16_f32 v169, v254, v255
    v_accvgpr_write_b32 a200, v168
    v_accvgpr_write_b32 a201, v169
    v_lshlrev_b32 v252, 16, v170
    v_and_b32 v253, s33, v170
    v_lshlrev_b32 v254, 16, v171
    v_and_b32 v255, s33, v171
    v_pk_mul_f32 v[252:253], v[252:253], s[34:35]
    v_pk_mul_f32 v[254:255], v[254:255], s[34:35]
    v_cvt_pk_bf16_f32 v170, v252, v253
    v_cvt_pk_bf16_f32 v171, v254, v255
    v_accvgpr_write_b32 a202, v170
    v_accvgpr_write_b32 a203, v171
    s_waitcnt lgkmcnt(4)
    v_lshlrev_b32 v252, 16, v172
    v_and_b32 v253, s33, v172
    v_lshlrev_b32 v254, 16, v173
    v_and_b32 v255, s33, v173
    v_pk_mul_f32 v[252:253], v[252:253], s[34:35]
    v_pk_mul_f32 v[254:255], v[254:255], s[34:35]
    v_cvt_pk_bf16_f32 v172, v252, v253
    v_cvt_pk_bf16_f32 v173, v254, v255
    v_accvgpr_write_b32 a204, v172
    v_accvgpr_write_b32 a205, v173
    v_lshlrev_b32 v252, 16, v174
    v_and_b32 v253, s33, v174
    v_lshlrev_b32 v254, 16, v175
    v_and_b32 v255, s33, v175
    v_pk_mul_f32 v[252:253], v[252:253], s[34:35]
    v_pk_mul_f32 v[254:255], v[254:255], s[34:35]
    v_cvt_pk_bf16_f32 v174, v252, v253
    v_cvt_pk_bf16_f32 v175, v254, v255
    v_accvgpr_write_b32 a206, v174
    v_accvgpr_write_b32 a207, v175
    s_waitcnt lgkmcnt(3)
    v_lshlrev_b32 v252, 16, v176
    v_and_b32 v253, s33, v176
    v_lshlrev_b32 v254, 16, v177
    v_and_b32 v255, s33, v177
    v_pk_mul_f32 v[252:253], v[252:253], s[34:35]
    v_pk_mul_f32 v[254:255], v[254:255], s[34:35]
    v_cvt_pk_bf16_f32 v176, v252, v253
    v_cvt_pk_bf16_f32 v177, v254, v255
    v_accvgpr_write_b32 a208, v176
    v_accvgpr_write_b32 a209, v177
    v_lshlrev_b32 v252, 16, v178
    v_and_b32 v253, s33, v178
    v_lshlrev_b32 v254, 16, v179
    v_and_b32 v255, s33, v179
    v_pk_mul_f32 v[252:253], v[252:253], s[34:35]
    v_pk_mul_f32 v[254:255], v[254:255], s[34:35]
    v_cvt_pk_bf16_f32 v178, v252, v253
    v_cvt_pk_bf16_f32 v179, v254, v255
    v_accvgpr_write_b32 a210, v178
    v_accvgpr_write_b32 a211, v179
    s_waitcnt lgkmcnt(2)
    v_lshlrev_b32 v252, 16, v180
    v_and_b32 v253, s33, v180
    v_lshlrev_b32 v254, 16, v181
    v_and_b32 v255, s33, v181
    v_pk_mul_f32 v[252:253], v[252:253], s[34:35]
    v_pk_mul_f32 v[254:255], v[254:255], s[34:35]
    v_cvt_pk_bf16_f32 v180, v252, v253
    v_cvt_pk_bf16_f32 v181, v254, v255
    v_accvgpr_write_b32 a212, v180
    v_accvgpr_write_b32 a213, v181
    v_lshlrev_b32 v252, 16, v182
    v_and_b32 v253, s33, v182
    v_lshlrev_b32 v254, 16, v183
    v_and_b32 v255, s33, v183
    v_pk_mul_f32 v[252:253], v[252:253], s[34:35]
    v_pk_mul_f32 v[254:255], v[254:255], s[34:35]
    v_cvt_pk_bf16_f32 v182, v252, v253
    v_cvt_pk_bf16_f32 v183, v254, v255
    v_accvgpr_write_b32 a214, v182
    v_accvgpr_write_b32 a215, v183
    s_waitcnt lgkmcnt(1)
    v_lshlrev_b32 v252, 16, v184
    v_and_b32 v253, s33, v184
    v_lshlrev_b32 v254, 16, v185
    v_and_b32 v255, s33, v185
    v_pk_mul_f32 v[252:253], v[252:253], s[34:35]
    v_pk_mul_f32 v[254:255], v[254:255], s[34:35]
    v_cvt_pk_bf16_f32 v184, v252, v253
    v_cvt_pk_bf16_f32 v185, v254, v255
    v_accvgpr_write_b32 a216, v184
    v_accvgpr_write_b32 a217, v185
    v_lshlrev_b32 v252, 16, v186
    v_and_b32 v253, s33, v186
    v_lshlrev_b32 v254, 16, v187
    v_and_b32 v255, s33, v187
    v_pk_mul_f32 v[252:253], v[252:253], s[34:35]
    v_pk_mul_f32 v[254:255], v[254:255], s[34:35]
    v_cvt_pk_bf16_f32 v186, v252, v253
    v_cvt_pk_bf16_f32 v187, v254, v255
    v_accvgpr_write_b32 a218, v186
    v_accvgpr_write_b32 a219, v187
    s_waitcnt lgkmcnt(0)
    v_lshlrev_b32 v252, 16, v188
    v_and_b32 v253, s33, v188
    v_lshlrev_b32 v254, 16, v189
    v_and_b32 v255, s33, v189
    v_pk_mul_f32 v[252:253], v[252:253], s[34:35]
    v_pk_mul_f32 v[254:255], v[254:255], s[34:35]
    v_cvt_pk_bf16_f32 v188, v252, v253
    v_cvt_pk_bf16_f32 v189, v254, v255
    v_accvgpr_write_b32 a220, v188
    v_accvgpr_write_b32 a221, v189
    v_lshlrev_b32 v252, 16, v190
    v_and_b32 v253, s33, v190
    v_lshlrev_b32 v254, 16, v191
    v_and_b32 v255, s33, v191
    v_pk_mul_f32 v[252:253], v[252:253], s[34:35]
    v_pk_mul_f32 v[254:255], v[254:255], s[34:35]
    v_cvt_pk_bf16_f32 v190, v252, v253
    v_cvt_pk_bf16_f32 v191, v254, v255
    v_accvgpr_write_b32 a222, v190
    v_accvgpr_write_b32 a223, v191
    s_waitcnt vmcnt(4)
    ds_read_b128 v[160:163], v136 offset:8192
    ds_read_b128 v[164:167], v137 offset:8192
    ds_read_b128 v[168:171], v138 offset:8192
    ds_read_b128 v[172:175], v139 offset:8192
    ds_read_b128 v[176:179], v136 offset:8448
    ds_read_b128 v[180:183], v137 offset:8448
    ds_read_b128 v[184:187], v138 offset:8448
    ds_read_b128 v[188:191], v139 offset:8448
    s_add_u32 m0, s27, 32768
    s_nop 0
    buffer_load_dwordx4 v236, s[8:11], s22 offen offset:0 nt lds
    buffer_load_dwordx4 v237, s[8:11], s22 offen offset:1024 nt lds
    buffer_load_dwordx4 v238, s[8:11], s22 offen offset:2048 nt lds
    buffer_load_dwordx4 v239, s[8:11], s22 offen offset:3072 nt lds
    s_add_u32 s22, s22, 16384
    s_add_u32 m0, s28, 0
    s_nop 0
    buffer_load_dwordx4 v240, s[12:15], s23 offen offset:0 nt lds
    buffer_load_dwordx4 v241, s[12:15], s23 offen offset:1024 nt lds
    buffer_load_dwordx4 v242, s[12:15], s23 offen offset:2048 nt lds
    buffer_load_dwordx4 v243, s[12:15], s23 offen offset:3072 nt lds
    s_add_u32 s23, s23, 16384
    s_waitcnt lgkmcnt(7)
    v_lshlrev_b32 v252, 16, v160
    v_and_b32 v253, s33, v160
    v_lshlrev_b32 v254, 16, v161
    v_and_b32 v255, s33, v161
    v_pk_mul_f32 v[252:253], v[252:253], s[34:35]
    v_pk_mul_f32 v[254:255], v[254:255], s[34:35]
    v_cvt_pk_bf16_f32 v160, v252, v253
    v_cvt_pk_bf16_f32 v161, v254, v255
    v_accvgpr_write_b32 a224, v160
    v_accvgpr_write_b32 a225, v161
    v_lshlrev_b32 v252, 16, v162
    v_and_b32 v253, s33, v162
    v_lshlrev_b32 v254, 16, v163
    v_and_b32 v255, s33, v163
    v_pk_mul_f32 v[252:253], v[252:253], s[34:35]
    v_pk_mul_f32 v[254:255], v[254:255], s[34:35]
    v_cvt_pk_bf16_f32 v162, v252, v253
    v_cvt_pk_bf16_f32 v163, v254, v255
    v_accvgpr_write_b32 a226, v162
    v_accvgpr_write_b32 a227, v163
    s_waitcnt lgkmcnt(6)
    v_lshlrev_b32 v252, 16, v164
    v_and_b32 v253, s33, v164
    v_lshlrev_b32 v254, 16, v165
    v_and_b32 v255, s33, v165
    v_pk_mul_f32 v[252:253], v[252:253], s[34:35]
    v_pk_mul_f32 v[254:255], v[254:255], s[34:35]
    v_cvt_pk_bf16_f32 v164, v252, v253
    v_cvt_pk_bf16_f32 v165, v254, v255
    v_accvgpr_write_b32 a228, v164
    v_accvgpr_write_b32 a229, v165
    v_lshlrev_b32 v252, 16, v166
    v_and_b32 v253, s33, v166
    v_lshlrev_b32 v254, 16, v167
    v_and_b32 v255, s33, v167
    v_pk_mul_f32 v[252:253], v[252:253], s[34:35]
    v_pk_mul_f32 v[254:255], v[254:255], s[34:35]
    v_cvt_pk_bf16_f32 v166, v252, v253
    v_cvt_pk_bf16_f32 v167, v254, v255
    v_accvgpr_write_b32 a230, v166
    v_accvgpr_write_b32 a231, v167
    s_waitcnt lgkmcnt(5)
    v_lshlrev_b32 v252, 16, v168
    v_and_b32 v253, s33, v168
    v_lshlrev_b32 v254, 16, v169
    v_and_b32 v255, s33, v169
    v_pk_mul_f32 v[252:253], v[252:253], s[34:35]
    v_pk_mul_f32 v[254:255], v[254:255], s[34:35]
    v_cvt_pk_bf16_f32 v168, v252, v253
    v_cvt_pk_bf16_f32 v169, v254, v255
    v_accvgpr_write_b32 a232, v168
    v_accvgpr_write_b32 a233, v169
    v_lshlrev_b32 v252, 16, v170
    v_and_b32 v253, s33, v170
    v_lshlrev_b32 v254, 16, v171
    v_and_b32 v255, s33, v171
    v_pk_mul_f32 v[252:253], v[252:253], s[34:35]
    v_pk_mul_f32 v[254:255], v[254:255], s[34:35]
    v_cvt_pk_bf16_f32 v170, v252, v253
    v_cvt_pk_bf16_f32 v171, v254, v255
    v_accvgpr_write_b32 a234, v170
    v_accvgpr_write_b32 a235, v171
    s_waitcnt lgkmcnt(4)
    v_lshlrev_b32 v252, 16, v172
    v_and_b32 v253, s33, v172
    v_lshlrev_b32 v254, 16, v173
    v_and_b32 v255, s33, v173
    v_pk_mul_f32 v[252:253], v[252:253], s[34:35]
    v_pk_mul_f32 v[254:255], v[254:255], s[34:35]
    v_cvt_pk_bf16_f32 v172, v252, v253
    v_cvt_pk_bf16_f32 v173, v254, v255
    v_accvgpr_write_b32 a236, v172
    v_accvgpr_write_b32 a237, v173
    v_lshlrev_b32 v252, 16, v174
    v_and_b32 v253, s33, v174
    v_lshlrev_b32 v254, 16, v175
    v_and_b32 v255, s33, v175
    v_pk_mul_f32 v[252:253], v[252:253], s[34:35]
    v_pk_mul_f32 v[254:255], v[254:255], s[34:35]
    v_cvt_pk_bf16_f32 v174, v252, v253
    v_cvt_pk_bf16_f32 v175, v254, v255
    v_accvgpr_write_b32 a238, v174
    v_accvgpr_write_b32 a239, v175
    s_waitcnt lgkmcnt(3)
    v_lshlrev_b32 v252, 16, v176
    v_and_b32 v253, s33, v176
    v_lshlrev_b32 v254, 16, v177
    v_and_b32 v255, s33, v177
    v_pk_mul_f32 v[252:253], v[252:253], s[34:35]
    v_pk_mul_f32 v[254:255], v[254:255], s[34:35]
    v_cvt_pk_bf16_f32 v176, v252, v253
    v_cvt_pk_bf16_f32 v177, v254, v255
    v_accvgpr_write_b32 a240, v176
    v_accvgpr_write_b32 a241, v177
    v_lshlrev_b32 v252, 16, v178
    v_and_b32 v253, s33, v178
    v_lshlrev_b32 v254, 16, v179
    v_and_b32 v255, s33, v179
    v_pk_mul_f32 v[252:253], v[252:253], s[34:35]
    v_pk_mul_f32 v[254:255], v[254:255], s[34:35]
    v_cvt_pk_bf16_f32 v178, v252, v253
    v_cvt_pk_bf16_f32 v179, v254, v255
    v_accvgpr_write_b32 a242, v178
    v_accvgpr_write_b32 a243, v179
    s_waitcnt lgkmcnt(2)
    v_lshlrev_b32 v252, 16, v180
    v_and_b32 v253, s33, v180
    v_lshlrev_b32 v254, 16, v181
    v_and_b32 v255, s33, v181
    v_pk_mul_f32 v[252:253], v[252:253], s[34:35]
    v_pk_mul_f32 v[254:255], v[254:255], s[34:35]
    v_cvt_pk_bf16_f32 v180, v252, v253
    v_cvt_pk_bf16_f32 v181, v254, v255
    v_accvgpr_write_b32 a244, v180
    v_accvgpr_write_b32 a245, v181
    v_lshlrev_b32 v252, 16, v182
    v_and_b32 v253, s33, v182
    v_lshlrev_b32 v254, 16, v183
    v_and_b32 v255, s33, v183
    v_pk_mul_f32 v[252:253], v[252:253], s[34:35]
    v_pk_mul_f32 v[254:255], v[254:255], s[34:35]
    v_cvt_pk_bf16_f32 v182, v252, v253
    v_cvt_pk_bf16_f32 v183, v254, v255
    v_accvgpr_write_b32 a246, v182
    v_accvgpr_write_b32 a247, v183
    s_waitcnt lgkmcnt(1)
    v_lshlrev_b32 v252, 16, v184
    v_and_b32 v253, s33, v184
    v_lshlrev_b32 v254, 16, v185
    v_and_b32 v255, s33, v185
    v_pk_mul_f32 v[252:253], v[252:253], s[34:35]
    v_pk_mul_f32 v[254:255], v[254:255], s[34:35]
    v_cvt_pk_bf16_f32 v184, v252, v253
    v_cvt_pk_bf16_f32 v185, v254, v255
    v_accvgpr_write_b32 a248, v184
    v_accvgpr_write_b32 a249, v185
    v_lshlrev_b32 v252, 16, v186
    v_and_b32 v253, s33, v186
    v_lshlrev_b32 v254, 16, v187
    v_and_b32 v255, s33, v187
    v_pk_mul_f32 v[252:253], v[252:253], s[34:35]
    v_pk_mul_f32 v[254:255], v[254:255], s[34:35]
    v_cvt_pk_bf16_f32 v186, v252, v253
    v_cvt_pk_bf16_f32 v187, v254, v255
    v_accvgpr_write_b32 a250, v186
    v_accvgpr_write_b32 a251, v187
    s_waitcnt lgkmcnt(0)
    v_lshlrev_b32 v252, 16, v188
    v_and_b32 v253, s33, v188
    v_lshlrev_b32 v254, 16, v189
    v_and_b32 v255, s33, v189
    v_pk_mul_f32 v[252:253], v[252:253], s[34:35]
    v_pk_mul_f32 v[254:255], v[254:255], s[34:35]
    v_cvt_pk_bf16_f32 v188, v252, v253
    v_cvt_pk_bf16_f32 v189, v254, v255
    v_accvgpr_write_b32 a252, v188
    v_accvgpr_write_b32 a253, v189
    v_lshlrev_b32 v252, 16, v190
    v_and_b32 v253, s33, v190
    v_lshlrev_b32 v254, 16, v191
    v_and_b32 v255, s33, v191
    v_pk_mul_f32 v[252:253], v[252:253], s[34:35]
    v_pk_mul_f32 v[254:255], v[254:255], s[34:35]
    v_cvt_pk_bf16_f32 v190, v252, v253
    v_cvt_pk_bf16_f32 v191, v254, v255
    v_accvgpr_write_b32 a254, v190
    v_accvgpr_write_b32 a255, v191
    s_barrier
    ds_read_b128 v[192:195], v224 offset:0
    ds_read_b128 v[196:199], v224 offset:8192
    ds_read_b128 v[200:203], v225 offset:0
    ds_read_b128 v[204:207], v225 offset:8192
    s_waitcnt lgkmcnt(3)
    v_mfma_f32_16x16x32_bf16 v[128:131], v[192:195], a[128:131], v[208:211]
    s_add_u32 m0, s27, 49152
    s_nop 0
    buffer_load_dwordx4 v236, s[8:11], s22 offen offset:0 nt lds
    v_mfma_f32_16x16x32_bf16 v[136:139], v[192:195], a[160:163], v[212:215]
    v_mfma_f32_16x16x32_bf16 v[144:147], v[192:195], a[192:195], v[216:219]
    buffer_load_dwordx4 v237, s[8:11], s22 offen offset:1024 nt lds
    v_mfma_f32_16x16x32_bf16 v[152:155], v[192:195], a[224:227], v[220:223]
    ds_read_b128 v[192:195], v226 offset:0
    s_waitcnt lgkmcnt(3)
    v_mfma_f32_16x16x32_bf16 v[132:135], v[196:199], a[128:131], v[208:211]
    buffer_load_dwordx4 v238, s[8:11], s22 offen offset:2048 nt lds
    v_mfma_f32_16x16x32_bf16 v[140:143], v[196:199], a[160:163], v[212:215]
    v_mfma_f32_16x16x32_bf16 v[148:151], v[196:199], a[192:195], v[216:219]
    buffer_load_dwordx4 v239, s[8:11], s22 offen offset:3072 nt lds
    s_add_u32 s22, s22, 16384
    v_mfma_f32_16x16x32_bf16 v[156:159], v[196:199], a[224:227], v[220:223]
    ds_read_b128 v[196:199], v226 offset:8192
    s_waitcnt lgkmcnt(3)
    v_mfma_f32_16x16x32_bf16 v[128:131], v[200:203], a[132:135], v[128:131]
    s_add_u32 m0, s28, 16384
    s_nop 0
    buffer_load_dwordx4 v240, s[12:15], s23 offen offset:0 nt lds
    v_mfma_f32_16x16x32_bf16 v[136:139], v[200:203], a[164:167], v[136:139]
    v_mfma_f32_16x16x32_bf16 v[144:147], v[200:203], a[196:199], v[144:147]
    buffer_load_dwordx4 v241, s[12:15], s23 offen offset:1024 nt lds
    v_mfma_f32_16x16x32_bf16 v[152:155], v[200:203], a[228:231], v[152:155]
    ds_read_b128 v[200:203], v227 offset:0
    s_waitcnt lgkmcnt(3)
    v_mfma_f32_16x16x32_bf16 v[132:135], v[204:207], a[132:135], v[132:135]
    buffer_load_dwordx4 v242, s[12:15], s23 offen offset:2048 nt lds
    v_mfma_f32_16x16x32_bf16 v[140:143], v[204:207], a[164:167], v[140:143]
    v_mfma_f32_16x16x32_bf16 v[148:151], v[204:207], a[196:199], v[148:151]
    buffer_load_dwordx4 v243, s[12:15], s23 offen offset:3072 nt lds
    s_add_u32 s23, s23, 16384
    v_mfma_f32_16x16x32_bf16 v[156:159], v[204:207], a[228:231], v[156:159]
    ds_read_b128 v[204:207], v227 offset:8192
    s_waitcnt lgkmcnt(3)
    v_mfma_f32_16x16x32_bf16 v[128:131], v[192:195], a[136:139], v[128:131]
    v_mfma_f32_16x16x32_bf16 v[136:139], v[192:195], a[168:171], v[136:139]
    v_mfma_f32_16x16x32_bf16 v[144:147], v[192:195], a[200:203], v[144:147]
    v_mfma_f32_16x16x32_bf16 v[152:155], v[192:195], a[232:235], v[152:155]
    ds_read_b128 v[192:195], v224 offset:256
    s_waitcnt lgkmcnt(3)
    v_mfma_f32_16x16x32_bf16 v[132:135], v[196:199], a[136:139], v[132:135]
    v_mfma_f32_16x16x32_bf16 v[140:143], v[196:199], a[168:171], v[140:143]
    v_mfma_f32_16x16x32_bf16 v[148:151], v[196:199], a[200:203], v[148:151]
    v_mfma_f32_16x16x32_bf16 v[156:159], v[196:199], a[232:235], v[156:159]
    ds_read_b128 v[196:199], v224 offset:8448
    s_waitcnt lgkmcnt(3)
    v_mfma_f32_16x16x32_bf16 v[128:131], v[200:203], a[140:143], v[128:131]
    v_mfma_f32_16x16x32_bf16 v[136:139], v[200:203], a[172:175], v[136:139]
    v_mfma_f32_16x16x32_bf16 v[144:147], v[200:203], a[204:207], v[144:147]
    v_mfma_f32_16x16x32_bf16 v[152:155], v[200:203], a[236:239], v[152:155]
    ds_read_b128 v[200:203], v225 offset:256
    s_waitcnt lgkmcnt(3)
    v_mfma_f32_16x16x32_bf16 v[132:135], v[204:207], a[140:143], v[132:135]
    v_mfma_f32_16x16x32_bf16 v[140:143], v[204:207], a[172:175], v[140:143]
    v_mfma_f32_16x16x32_bf16 v[148:151], v[204:207], a[204:207], v[148:151]
    v_mfma_f32_16x16x32_bf16 v[156:159], v[204:207], a[236:239], v[156:159]
    ds_read_b128 v[204:207], v225 offset:8448
    s_waitcnt lgkmcnt(3)
    v_mfma_f32_16x16x32_bf16 v[128:131], v[192:195], a[144:147], v[128:131]
    v_mfma_f32_16x16x32_bf16 v[136:139], v[192:195], a[176:179], v[136:139]
    v_mfma_f32_16x16x32_bf16 v[144:147], v[192:195], a[208:211], v[144:147]
    v_mfma_f32_16x16x32_bf16 v[152:155], v[192:195], a[240:243], v[152:155]
    ds_read_b128 v[192:195], v226 offset:256
    s_waitcnt lgkmcnt(3)
    v_mfma_f32_16x16x32_bf16 v[132:135], v[196:199], a[144:147], v[132:135]
    v_mfma_f32_16x16x32_bf16 v[140:143], v[196:199], a[176:179], v[140:143]
    v_mfma_f32_16x16x32_bf16 v[148:151], v[196:199], a[208:211], v[148:151]
    v_mfma_f32_16x16x32_bf16 v[156:159], v[196:199], a[240:243], v[156:159]
    ds_read_b128 v[196:199], v226 offset:8448
    s_waitcnt lgkmcnt(3)
    v_mfma_f32_16x16x32_bf16 v[128:131], v[200:203], a[148:151], v[128:131]
    v_mfma_f32_16x16x32_bf16 v[136:139], v[200:203], a[180:183], v[136:139]
    v_mfma_f32_16x16x32_bf16 v[144:147], v[200:203], a[212:215], v[144:147]
    v_mfma_f32_16x16x32_bf16 v[152:155], v[200:203], a[244:247], v[152:155]
    ds_read_b128 v[200:203], v227 offset:256
    s_waitcnt lgkmcnt(3)
    v_mfma_f32_16x16x32_bf16 v[132:135], v[204:207], a[148:151], v[132:135]
    v_mfma_f32_16x16x32_bf16 v[140:143], v[204:207], a[180:183], v[140:143]
    v_mfma_f32_16x16x32_bf16 v[148:151], v[204:207], a[212:215], v[148:151]
    v_mfma_f32_16x16x32_bf16 v[156:159], v[204:207], a[244:247], v[156:159]
    ds_read_b128 v[204:207], v227 offset:8448
    s_waitcnt lgkmcnt(3)
    v_mfma_f32_16x16x32_bf16 v[128:131], v[192:195], a[152:155], v[128:131]
    v_mfma_f32_16x16x32_bf16 v[136:139], v[192:195], a[184:187], v[136:139]
    v_mfma_f32_16x16x32_bf16 v[144:147], v[192:195], a[216:219], v[144:147]
    v_mfma_f32_16x16x32_bf16 v[152:155], v[192:195], a[248:251], v[152:155]
    s_waitcnt lgkmcnt(0)
    s_waitcnt vmcnt(16)
    s_barrier
    ds_read_b128 v[192:195], v224 offset:16384
    v_mfma_f32_16x16x32_bf16 v[132:135], v[196:199], a[152:155], v[132:135]
    v_mfma_f32_16x16x32_bf16 v[140:143], v[196:199], a[184:187], v[140:143]
    s_add_u32 m0, s27, 0
    s_nop 0
    buffer_load_dwordx4 v236, s[8:11], s22 offen offset:0 nt lds
    v_mfma_f32_16x16x32_bf16 v[148:151], v[196:199], a[216:219], v[148:151]
    v_mfma_f32_16x16x32_bf16 v[156:159], v[196:199], a[248:251], v[156:159]
    ds_read_b128 v[196:199], v224 offset:24576
    v_mfma_f32_16x16x32_bf16 v[128:131], v[200:203], a[156:159], v[128:131]
    v_mfma_f32_16x16x32_bf16 v[136:139], v[200:203], a[188:191], v[136:139]
    buffer_load_dwordx4 v237, s[8:11], s22 offen offset:1024 nt lds
    v_mfma_f32_16x16x32_bf16 v[144:147], v[200:203], a[220:223], v[144:147]
    v_mfma_f32_16x16x32_bf16 v[152:155], v[200:203], a[252:255], v[152:155]
    ds_read_b128 v[200:203], v225 offset:16384
    v_mfma_f32_16x16x32_bf16 v[132:135], v[204:207], a[156:159], v[132:135]
    v_mfma_f32_16x16x32_bf16 v[140:143], v[204:207], a[188:191], v[140:143]
    buffer_load_dwordx4 v238, s[8:11], s22 offen offset:2048 nt lds
    v_mfma_f32_16x16x32_bf16 v[148:151], v[204:207], a[220:223], v[148:151]
    v_mfma_f32_16x16x32_bf16 v[156:159], v[204:207], a[252:255], v[156:159]
    ds_read_b128 v[204:207], v225 offset:24576
    s_branch L_stub_0
L_back_0:
    s_waitcnt lgkmcnt(2)
    v_mfma_f32_16x16x32_bf16 v[160:163], v[192:195], a[128:131], v[208:211]
    v_mfma_f32_16x16x32_bf16 v[168:171], v[192:195], a[160:163], v[212:215]
    buffer_load_dwordx4 v239, s[8:11], s22 offen offset:3072 nt lds
    s_add_u32 s22, s22, 16384
    v_mfma_f32_16x16x32_bf16 v[176:179], v[192:195], a[192:195], v[216:219]
    v_mfma_f32_16x16x32_bf16 v[184:187], v[192:195], a[224:227], v[220:223]
    ds_read_b128 v[192:195], v226 offset:16384
    v_mfma_f32_16x16x32_bf16 v[164:167], v[196:199], a[128:131], v[208:211]
    v_mfma_f32_16x16x32_bf16 v[172:175], v[196:199], a[160:163], v[212:215]
    s_add_u32 m0, s28, 32768
    s_nop 0
    buffer_load_dwordx4 v240, s[12:15], s23 offen offset:0 nt lds
    v_mfma_f32_16x16x32_bf16 v[180:183], v[196:199], a[192:195], v[216:219]
    v_exp_f32 v128, v128
    v_mfma_f32_16x16x32_bf16 v[188:191], v[196:199], a[224:227], v[220:223]
    ds_read_b128 v[196:199], v226 offset:24576
    s_waitcnt lgkmcnt(2)
    v_mfma_f32_16x16x32_bf16 v[160:163], v[200:203], a[132:135], v[160:163]
    v_exp_f32 v129, v129
    v_mfma_f32_16x16x32_bf16 v[168:171], v[200:203], a[164:167], v[168:171]
    buffer_load_dwordx4 v241, s[12:15], s23 offen offset:1024 nt lds
    v_mfma_f32_16x16x32_bf16 v[176:179], v[200:203], a[196:199], v[176:179]
    v_add_f32 v244, v244, v128
    v_add_f32 v244, v244, v129
    v_mfma_f32_16x16x32_bf16 v[184:187], v[200:203], a[228:231], v[184:187]
    ds_read_b128 v[200:203], v227 offset:16384
    v_cvt_pk_bf16_f32 v128, v128, v129
    v_mfma_f32_16x16x32_bf16 v[164:167], v[204:207], a[132:135], v[164:167]
    v_exp_f32 v130, v130
    v_mfma_f32_16x16x32_bf16 v[172:175], v[204:207], a[164:167], v[172:175]
    buffer_load_dwordx4 v242, s[12:15], s23 offen offset:2048 nt lds
    v_mfma_f32_16x16x32_bf16 v[180:183], v[204:207], a[196:199], v[180:183]
    v_exp_f32 v131, v131
    v_mfma_f32_16x16x32_bf16 v[188:191], v[204:207], a[228:231], v[188:191]
    ds_read_b128 v[204:207], v227 offset:24576
    s_waitcnt lgkmcnt(2)
    v_mfma_f32_16x16x32_bf16 v[160:163], v[192:195], a[136:139], v[160:163]
    v_add_f32 v244, v244, v130
    v_add_f32 v244, v244, v131
    v_mfma_f32_16x16x32_bf16 v[168:171], v[192:195], a[168:171], v[168:171]
    buffer_load_dwordx4 v243, s[12:15], s23 offen offset:3072 nt lds
    s_add_u32 s23, s23, 16384
    v_mfma_f32_16x16x32_bf16 v[176:179], v[192:195], a[200:203], v[176:179]
    v_exp_f32 v132, v132
    v_mfma_f32_16x16x32_bf16 v[184:187], v[192:195], a[232:235], v[184:187]
    ds_read_b128 v[192:195], v224 offset:16640
    v_cvt_pk_bf16_f32 v129, v130, v131
    v_mfma_f32_16x16x32_bf16 v[164:167], v[196:199], a[136:139], v[164:167]
    v_exp_f32 v133, v133
    v_mfma_f32_16x16x32_bf16 v[172:175], v[196:199], a[168:171], v[172:175]
    v_add_f32 v244, v244, v132
    v_add_f32 v244, v244, v133
    v_mfma_f32_16x16x32_bf16 v[180:183], v[196:199], a[200:203], v[180:183]
    v_exp_f32 v134, v134
    v_mfma_f32_16x16x32_bf16 v[188:191], v[196:199], a[232:235], v[188:191]
    ds_read_b128 v[196:199], v224 offset:24832
    s_waitcnt lgkmcnt(2)
    v_mfma_f32_16x16x32_bf16 v[160:163], v[200:203], a[140:143], v[160:163]
    v_cvt_pk_bf16_f32 v130, v132, v133
    v_add_f32 v244, v244, v134
    v_mfma_f32_16x16x32_bf16 v[168:171], v[200:203], a[172:175], v[168:171]
    v_exp_f32 v135, v135
    v_mfma_f32_16x16x32_bf16 v[176:179], v[200:203], a[204:207], v[176:179]
    v_add_f32 v244, v244, v135
    v_cvt_pk_bf16_f32 v131, v134, v135
    v_mfma_f32_16x16x32_bf16 v[184:187], v[200:203], a[236:239], v[184:187]
    ds_read_b128 v[200:203], v225 offset:16640
    v_mfma_f32_16x16x32_bf16 v[164:167], v[204:207], a[140:143], v[164:167]
    v_exp_f32 v136, v136
    v_mfma_f32_16x16x32_bf16 v[172:175], v[204:207], a[172:175], v[172:175]
    v_exp_f32 v137, v137
    v_mfma_f32_16x16x32_bf16 v[180:183], v[204:207], a[204:207], v[180:183]
    v_add_f32 v245, v245, v136
    v_add_f32 v245, v245, v137
    v_mfma_f32_16x16x32_bf16 v[188:191], v[204:207], a[236:239], v[188:191]
    ds_read_b128 v[204:207], v225 offset:24832
    s_waitcnt lgkmcnt(2)
    v_mfma_f32_16x16x32_bf16 v[160:163], v[192:195], a[144:147], v[160:163]
    v_exp_f32 v138, v138
    v_mfma_f32_16x16x32_bf16 v[168:171], v[192:195], a[176:179], v[168:171]
    v_cvt_pk_bf16_f32 v136, v136, v137
    v_add_f32 v245, v245, v138
    v_mfma_f32_16x16x32_bf16 v[176:179], v[192:195], a[208:211], v[176:179]
    v_exp_f32 v139, v139
    v_mfma_f32_16x16x32_bf16 v[184:187], v[192:195], a[240:243], v[184:187]
    ds_read_b128 v[192:195], v226 offset:16640
    v_add_f32 v245, v245, v139
    v_mfma_f32_16x16x32_bf16 v[164:167], v[196:199], a[144:147], v[164:167]
    v_exp_f32 v140, v140
    v_mfma_f32_16x16x32_bf16 v[172:175], v[196:199], a[176:179], v[172:175]
    v_cvt_pk_bf16_f32 v137, v138, v139
    v_add_f32 v245, v245, v140
    v_mfma_f32_16x16x32_bf16 v[180:183], v[196:199], a[208:211], v[180:183]
    v_exp_f32 v141, v141
    v_mfma_f32_16x16x32_bf16 v[188:191], v[196:199], a[240:243], v[188:191]
    ds_read_b128 v[196:199], v226 offset:24832
    s_waitcnt lgkmcnt(2)
    v_mfma_f32_16x16x32_bf16 v[160:163], v[200:203], a[148:151], v[160:163]
    v_exp_f32 v142, v142
    v_mfma_f32_16x16x32_bf16 v[168:171], v[200:203], a[180:183], v[168:171]
    v_add_f32 v245, v245, v141
    v_cvt_pk_bf16_f32 v138, v140, v141
    v_mfma_f32_16x16x32_bf16 v[176:179], v[200:203], a[212:215], v[176:179]
    v_exp_f32 v143, v143
    v_mfma_f32_16x16x32_bf16 v[184:187], v[200:203], a[244:247], v[184:187]
    ds_read_b128 v[200:203], v227 offset:16640
    v_add_f32 v245, v245, v142
    v_mfma_f32_16x16x32_bf16 v[164:167], v[204:207], a[148:151], v[164:167]
    v_add_f32 v245, v245, v143
    v_cvt_pk_bf16_f32 v139, v142, v143
    v_mfma_f32_16x16x32_bf16 v[172:175], v[204:207], a[180:183], v[172:175]
    v_exp_f32 v144, v144
    v_mfma_f32_16x16x32_bf16 v[180:183], v[204:207], a[212:215], v[180:183]
    v_exp_f32 v145, v145
    v_mfma_f32_16x16x32_bf16 v[188:191], v[204:207], a[244:247], v[188:191]
    ds_read_b128 v[204:207], v227 offset:24832
    s_waitcnt lgkmcnt(3)
    v_mfma_f32_16x16x32_bf16 v[160:163], v[192:195], a[152:155], v[160:163]
    v_add_f32 v246, v246, v144
    v_add_f32 v246, v246, v145
    v_mfma_f32_16x16x32_bf16 v[168:171], v[192:195], a[184:187], v[168:171]
    v_exp_f32 v146, v146
    v_cvt_pk_bf16_f32 v144, v144, v145
    v_exp_f32 v147, v147
    v_add_f32 v246, v246, v146
    v_exp_f32 v148, v148
    v_add_f32 v246, v246, v147
    v_cvt_pk_bf16_f32 v145, v146, v147
    v_exp_f32 v149, v149
    v_add_f32 v246, v246, v148
    v_exp_f32 v150, v150
    v_add_f32 v246, v246, v149
    v_cvt_pk_bf16_f32 v146, v148, v149
    v_exp_f32 v151, v151
    v_add_f32 v246, v246, v150
    v_add_f32 v246, v246, v151
    v_cvt_pk_bf16_f32 v147, v150, v151
    v_exp_f32 v152, v152
    v_exp_f32 v153, v153
    v_add_f32 v247, v247, v152
    v_exp_f32 v154, v154
    v_add_f32 v247, v247, v153
    v_cvt_pk_bf16_f32 v152, v152, v153
    v_exp_f32 v155, v155
    v_add_f32 v247, v247, v154
    v_exp_f32 v156, v156
    v_add_f32 v247, v247, v155
    v_cvt_pk_bf16_f32 v153, v154, v155
    v_exp_f32 v157, v157
    v_add_f32 v247, v247, v156
    v_exp_f32 v158, v158
    v_add_f32 v247, v247, v157
    v_cvt_pk_bf16_f32 v154, v156, v157
    v_exp_f32 v159, v159
    v_add_f32 v247, v247, v158
    v_add_f32 v247, v247, v159
    v_cvt_pk_bf16_f32 v155, v158, v159
    v_mfma_f32_16x16x32_bf16 v[176:179], v[192:195], a[216:219], v[176:179]
    v_mfma_f32_16x16x32_bf16 v[184:187], v[192:195], a[248:251], v[184:187]
    s_waitcnt lgkmcnt(0)
    s_waitcnt vmcnt(16)
    s_barrier
    s_mov_b32 s31, 0
    s_mov_b32 s25, 0
    v_mov_b32 v248, 1.0
    v_mov_b32 v249, 1.0
    v_mov_b32 v250, 1.0
    v_mov_b32 v251, 1.0
    s_mov_b32 s24, 7
.p2align 6
L_loop:
    ds_read_b64_tr_b16 v[192:193], v228 offset:0
    ds_read_b64_tr_b16 v[194:195], v228 offset:8192
    v_mfma_f32_16x16x32_bf16 v[164:167], v[196:199], a[152:155], v[164:167]
    v_mfma_f32_16x16x32_bf16 v[172:175], v[196:199], a[184:187], v[172:175]
    s_add_u32 m0, s27, 16384
    s_nop 0
    buffer_load_dwordx4 v236, s[8:11], s22 offen offset:0 nt lds
    v_mfma_f32_16x16x32_bf16 v[180:183], v[196:199], a[216:219], v[180:183]
    v_mfma_f32_16x16x32_bf16 v[188:191], v[196:199], a[248:251], v[188:191]
    ds_read_b64_tr_b16 v[196:197], v229 offset:0
    ds_read_b64_tr_b16 v[198:199], v229 offset:8192
    v_mfma_f32_16x16x32_bf16 v[160:163], v[200:203], a[156:159], v[160:163]
    v_mfma_f32_16x16x32_bf16 v[168:171], v[200:203], a[188:191], v[168:171]
    buffer_load_dwordx4 v237, s[8:11], s22 offen offset:1024 nt lds
    v_mfma_f32_16x16x32_bf16 v[176:179], v[200:203], a[220:223], v[176:179]
    v_mfma_f32_16x16x32_bf16 v[184:187], v[200:203], a[252:255], v[184:187]
    ds_read_b64_tr_b16 v[200:201], v230 offset:0
    ds_read_b64_tr_b16 v[202:203], v230 offset:8192
    v_mfma_f32_16x16x32_bf16 v[164:167], v[204:207], a[156:159], v[164:167]
    v_mfma_f32_16x16x32_bf16 v[172:175], v[204:207], a[188:191], v[172:175]
    buffer_load_dwordx4 v238, s[8:11], s22 offen offset:2048 nt lds
    v_mfma_f32_16x16x32_bf16 v[180:183], v[204:207], a[220:223], v[180:183]
    v_mfma_f32_16x16x32_bf16 v[188:191], v[204:207], a[252:255], v[188:191]
    s_cmp_lg_u32 s25, 0
    s_cbranch_scc1 L_stub_1
L_back_1:
    s_waitcnt lgkmcnt(2)
    v_mfma_f32_16x16x32_bf16 v[0:3], v[192:195], v[128:131], v[0:3]
    ds_read_b64_tr_b16 v[204:205], v231 offset:0
    ds_read_b64_tr_b16 v[206:207], v231 offset:8192
    v_mfma_f32_16x16x32_bf16 v[64:67], v[192:195], v[136:139], v[64:67]
    buffer_load_dwordx4 v239, s[8:11], s22 offen offset:3072 nt lds
    s_add_u32 s22, s22, 16384
    v_mfma_f32_16x16x32_bf16 a[0:3], v[192:195], v[144:147], a[0:3]
    v_mfma_f32_16x16x32_bf16 a[64:67], v[192:195], v[152:155], a[64:67]
    ds_read_b64_tr_b16 v[192:193], v232 offset:0
    ds_read_b64_tr_b16 v[194:195], v232 offset:8192
    v_mfma_f32_16x16x32_bf16 v[4:7], v[196:199], v[128:131], v[4:7]
    v_mfma_f32_16x16x32_bf16 v[68:71], v[196:199], v[136:139], v[68:71]
    s_add_u32 m0, s28, 49152
    s_nop 0
    buffer_load_dwordx4 v240, s[12:15], s23 offen offset:0 nt lds
    v_mfma_f32_16x16x32_bf16 a[4:7], v[196:199], v[144:147], a[4:7]
    v_max3_f32 v252, v160, v161, v162
    v_max3_f32 v253, v163, v164, v165
    v_mfma_f32_16x16x32_bf16 a[68:71], v[196:199], v[152:155], a[68:71]
    ds_read_b64_tr_b16 v[196:197], v233 offset:0
    s_waitcnt lgkmcnt(3)
    v_mfma_f32_16x16x32_bf16 v[8:11], v[200:203], v[128:131], v[8:11]
    ds_read_b64_tr_b16 v[198:199], v233 offset:8192
    v_max3_f32 v252, v252, v166, v167
    v_mfma_f32_16x16x32_bf16 v[72:75], v[200:203], v[136:139], v[72:75]
    buffer_load_dwordx4 v241, s[12:15], s23 offen offset:1024 nt lds
    v_mfma_f32_16x16x32_bf16 a[8:11], v[200:203], v[144:147], a[8:11]
    v_max3_f32 v253, v253, v168, v169
    v_max3_f32 v252, v252, v170, v171
    v_mfma_f32_16x16x32_bf16 a[72:75], v[200:203], v[152:155], a[72:75]
    ds_read_b64_tr_b16 v[200:201], v234 offset:0
    ds_read_b64_tr_b16 v[202:203], v234 offset:8192
    v_mfma_f32_16x16x32_bf16 v[12:15], v[204:207], v[128:131], v[12:15]
    v_max3_f32 v253, v253, v172, v173
    v_max3_f32 v252, v252, v174, v175
    v_mfma_f32_16x16x32_bf16 v[76:79], v[204:207], v[136:139], v[76:79]
    buffer_load_dwordx4 v242, s[12:15], s23 offen offset:2048 nt lds
    v_mfma_f32_16x16x32_bf16 a[12:15], v[204:207], v[144:147], a[12:15]
    v_max3_f32 v253, v253, v176, v177
    v_max3_f32 v252, v252, v178, v179
    v_mfma_f32_16x16x32_bf16 a[76:79], v[204:207], v[152:155], a[76:79]
    ds_read_b64_tr_b16 v[204:205], v235 offset:0
    s_waitcnt lgkmcnt(3)
    v_mfma_f32_16x16x32_bf16 v[16:19], v[192:195], v[128:131], v[16:19]
    ds_read_b64_tr_b16 v[206:207], v235 offset:8192
    v_max3_f32 v253, v253, v180, v181
    v_mfma_f32_16x16x32_bf16 v[80:83], v[192:195], v[136:139], v[80:83]
    buffer_load_dwordx4 v243, s[12:15], s23 offen offset:3072 nt lds
    s_add_u32 s23, s23, 16384
    v_mfma_f32_16x16x32_bf16 a[16:19], v[192:195], v[144:147], a[16:19]
    v_max3_f32 v252, v252, v182, v183
    v_max3_f32 v253, v253, v184, v185
    v_mfma_f32_16x16x32_bf16 a[80:83], v[192:195], v[152:155], a[80:83]
    ds_read_b64_tr_b16 v[192:193], v228 offset:256
    ds_read_b64_tr_b16 v[194:195], v228 offset:8448
    v_mfma_f32_16x16x32_bf16 v[20:23], v[196:199], v[128:131], v[20:23]
    v_max3_f32 v252, v252, v186, v187
    v_max3_f32 v253, v253, v188, v189
    v_mfma_f32_16x16x32_bf16 v[84:87], v[196:199], v[136:139], v[84:87]
    v_max3_f32 v252, v252, v190, v191
    v_max_f32 v252, v252, v253
    v_mfma_f32_16x16x32_bf16 a[20:23], v[196:199], v[144:147], a[20:23]
    v_cmp_lt_f32 vcc, s32, v252
    s_cbranch_vccnz L_stub_2
L_back_2:
    v_mfma_f32_16x16x32_bf16 a[84:87], v[196:199], v[152:155], a[84:87]
    ds_read_b64_tr_b16 v[196:197], v229 offset:256
    s_waitcnt lgkmcnt(3)
    v_mfma_f32_16x16x32_bf16 v[24:27], v[200:203], v[128:131], v[24:27]
    ds_read_b64_tr_b16 v[198:199], v229 offset:8448
    v_mfma_f32_16x16x32_bf16 v[88:91], v[200:203], v[136:139], v[88:91]
    v_exp_f32 v160, v160
    v_mfma_f32_16x16x32_bf16 a[24:27], v[200:203], v[144:147], a[24:27]
    v_exp_f32 v161, v161
    v_mfma_f32_16x16x32_bf16 a[88:91], v[200:203], v[152:155], a[88:91]
    ds_read_b64_tr_b16 v[200:201], v230 offset:256
    ds_read_b64_tr_b16 v[202:203], v230 offset:8448
    v_mfma_f32_16x16x32_bf16 v[28:31], v[204:207], v[128:131], v[28:31]
    v_add_f32 v244, v244, v160
    v_add_f32 v244, v244, v161
    v_mfma_f32_16x16x32_bf16 v[92:95], v[204:207], v[136:139], v[92:95]
    v_exp_f32 v162, v162
    v_mfma_f32_16x16x32_bf16 a[28:31], v[204:207], v[144:147], a[28:31]
    v_cvt_pk_bf16_f32 v160, v160, v161
    v_add_f32 v244, v244, v162
    v_mfma_f32_16x16x32_bf16 a[92:95], v[204:207], v[152:155], a[92:95]
    ds_read_b64_tr_b16 v[204:205], v231 offset:256
    s_waitcnt lgkmcnt(3)
    v_mfma_f32_16x16x32_bf16 v[32:35], v[192:195], v[128:131], v[32:35]
    ds_read_b64_tr_b16 v[206:207], v231 offset:8448
    v_mfma_f32_16x16x32_bf16 v[96:99], v[192:195], v[136:139], v[96:99]
    v_exp_f32 v163, v163
    v_mfma_f32_16x16x32_bf16 a[32:35], v[192:195], v[144:147], a[32:35]
    v_exp_f32 v164, v164
    v_mfma_f32_16x16x32_bf16 a[96:99], v[192:195], v[152:155], a[96:99]
    ds_read_b64_tr_b16 v[192:193], v232 offset:256
    ds_read_b64_tr_b16 v[194:195], v232 offset:8448
    v_mfma_f32_16x16x32_bf16 v[36:39], v[196:199], v[128:131], v[36:39]
    v_add_f32 v244, v244, v163
    v_cvt_pk_bf16_f32 v161, v162, v163
    v_mfma_f32_16x16x32_bf16 v[100:103], v[196:199], v[136:139], v[100:103]
    v_exp_f32 v165, v165
    v_mfma_f32_16x16x32_bf16 a[36:39], v[196:199], v[144:147], a[36:39]
    v_add_f32 v244, v244, v164
    v_add_f32 v244, v244, v165
    v_mfma_f32_16x16x32_bf16 a[100:103], v[196:199], v[152:155], a[100:103]
    ds_read_b64_tr_b16 v[196:197], v233 offset:256
    s_waitcnt lgkmcnt(3)
    v_mfma_f32_16x16x32_bf16 v[40:43], v[200:203], v[128:131], v[40:43]
    ds_read_b64_tr_b16 v[198:199], v233 offset:8448
    v_cvt_pk_bf16_f32 v162, v164, v165
    v_mfma_f32_16x16x32_bf16 v[104:107], v[200:203], v[136:139], v[104:107]
    v_exp_f32 v166, v166
    v_mfma_f32_16x16x32_bf16 a[40:43], v[200:203], v[144:147], a[40:43]
    v_exp_f32 v167, v167
    v_mfma_f32_16x16x32_bf16 a[104:107], v[200:203], v[152:155], a[104:107]
    ds_read_b64_tr_b16 v[200:201], v234 offset:256
    ds_read_b64_tr_b16 v[202:203], v234 offset:8448
    v_mfma_f32_16x16x32_bf16 v[44:47], v[204:207], v[128:131], v[44:47]
    v_add_f32 v244, v244, v166
    v_add_f32 v244, v244, v167
    v_mfma_f32_16x16x32_bf16 v[108:111], v[204:207], v[136:139], v[108:111]
    v_cvt_pk_bf16_f32 v163, v166, v167
    v_mfma_f32_16x16x32_bf16 a[44:47], v[204:207], v[144:147], a[44:47]
    v_exp_f32 v168, v168
    v_mfma_f32_16x16x32_bf16 a[108:111], v[204:207], v[152:155], a[108:111]
    ds_read_b64_tr_b16 v[204:205], v235 offset:256
    s_waitcnt lgkmcnt(3)
    v_mfma_f32_16x16x32_bf16 v[48:51], v[192:195], v[128:131], v[48:51]
    ds_read_b64_tr_b16 v[206:207], v235 offset:8448
    v_add_f32 v245, v245, v168
    v_mfma_f32_16x16x32_bf16 v[112:115], v[192:195], v[136:139], v[112:115]
    v_exp_f32 v169, v169
    v_mfma_f32_16x16x32_bf16 a[48:51], v[192:195], v[144:147], a[48:51]
    v_exp_f32 v170, v170
    v_mfma_f32_16x16x32_bf16 a[112:115], v[192:195], v[152:155], a[112:115]
    ds_read_b128 v[192:195], v224 offset:32768
    v_add_f32 v245, v245, v169
    v_mfma_f32_16x16x32_bf16 v[52:55], v[196:199], v[128:131], v[52:55]
    v_cvt_pk_bf16_f32 v168, v168, v169
    v_add_f32 v245, v245, v170
    v_mfma_f32_16x16x32_bf16 v[116:119], v[196:199], v[136:139], v[116:119]
    v_exp_f32 v171, v171
    v_mfma_f32_16x16x32_bf16 a[52:55], v[196:199], v[144:147], a[52:55]
    v_exp_f32 v172, v172
    v_mfma_f32_16x16x32_bf16 a[116:119], v[196:199], v[152:155], a[116:119]
    ds_read_b128 v[196:199], v224 offset:40960
    s_waitcnt lgkmcnt(2)
    v_mfma_f32_16x16x32_bf16 v[56:59], v[200:203], v[128:131], v[56:59]
    v_add_f32 v245, v245, v171
    v_cvt_pk_bf16_f32 v169, v170, v171
    v_mfma_f32_16x16x32_bf16 v[120:123], v[200:203], v[136:139], v[120:123]
    v_exp_f32 v173, v173
    v_mfma_f32_16x16x32_bf16 a[56:59], v[200:203], v[144:147], a[56:59]
    v_add_f32 v245, v245, v172
    v_add_f32 v245, v245, v173
    v_mfma_f32_16x16x32_bf16 a[120:123], v[200:203], v[152:155], a[120:123]
    ds_read_b128 v[200:203], v225 offset:32768
    v_cvt_pk_bf16_f32 v170, v172, v173
    v_mfma_f32_16x16x32_bf16 v[60:63], v[204:207], v[128:131], v[60:63]
    v_exp_f32 v174, v174
    v_mfma_f32_16x16x32_bf16 v[124:127], v[204:207], v[136:139], v[124:127]
    v_exp_f32 v175, v175
    v_mfma_f32_16x16x32_bf16 a[60:63], v[204:207], v[144:147], a[60:63]
    v_add_f32 v245, v245, v174
    v_add_f32 v245, v245, v175
    v_mfma_f32_16x16x32_bf16 a[124:127], v[204:207], v[152:155], a[124:127]
    ds_read_b128 v[204:207], v225 offset:40960
    s_waitcnt lgkmcnt(2)
    v_mfma_f32_16x16x32_bf16 v[128:131], v[192:195], a[128:131], v[208:211]
    v_cvt_pk_bf16_f32 v171, v174, v175
    v_mfma_f32_16x16x32_bf16 v[136:139], v[192:195], a[160:163], v[212:215]
    v_exp_f32 v176, v176
    v_mfma_f32_16x16x32_bf16 v[144:147], v[192:195], a[192:195], v[216:219]
    v_exp_f32 v177, v177
    v_mfma_f32_16x16x32_bf16 v[152:155], v[192:195], a[224:227], v[220:223]
    ds_read_b128 v[192:195], v226 offset:32768
    v_add_f32 v246, v246, v176
    v_mfma_f32_16x16x32_bf16 v[132:135], v[196:199], a[128:131], v[208:211]
    v_exp_f32 v178, v178
    v_mfma_f32_16x16x32_bf16 v[140:143], v[196:199], a[160:163], v[212:215]
    v_add_f32 v246, v246, v177
    v_cvt_pk_bf16_f32 v176, v176, v177
    v_mfma_f32_16x16x32_bf16 v[148:151], v[196:199], a[192:195], v[216:219]
    v_exp_f32 v179, v179
    v_mfma_f32_16x16x32_bf16 v[156:159], v[196:199], a[224:227], v[220:223]
    ds_read_b128 v[196:199], v226 offset:40960
    s_waitcnt lgkmcnt(2)
    v_mfma_f32_16x16x32_bf16 v[128:131], v[200:203], a[132:135], v[128:131]
    v_add_f32 v246, v246, v178
    v_add_f32 v246, v246, v179
    v_mfma_f32_16x16x32_bf16 v[136:139], v[200:203], a[164:167], v[136:139]
    v_exp_f32 v180, v180
    v_mfma_f32_16x16x32_bf16 v[144:147], v[200:203], a[196:199], v[144:147]
    v_cvt_pk_bf16_f32 v177, v178, v179
    v_add_f32 v246, v246, v180
    v_mfma_f32_16x16x32_bf16 v[152:155], v[200:203], a[228:231], v[152:155]
    ds_read_b128 v[200:203], v227 offset:32768
    v_mfma_f32_16x16x32_bf16 v[132:135], v[204:207], a[132:135], v[132:135]
    v_exp_f32 v181, v181
    v_mfma_f32_16x16x32_bf16 v[140:143], v[204:207], a[164:167], v[140:143]
    v_exp_f32 v182, v182
    v_mfma_f32_16x16x32_bf16 v[148:151], v[204:207], a[196:199], v[148:151]
    v_add_f32 v246, v246, v181
    v_cvt_pk_bf16_f32 v178, v180, v181
    v_mfma_f32_16x16x32_bf16 v[156:159], v[204:207], a[228:231], v[156:159]
    ds_read_b128 v[204:207], v227 offset:40960
    s_waitcnt lgkmcnt(2)
    v_mfma_f32_16x16x32_bf16 v[128:131], v[192:195], a[136:139], v[128:131]
    v_exp_f32 v183, v183
    v_mfma_f32_16x16x32_bf16 v[136:139], v[192:195], a[168:171], v[136:139]
    v_add_f32 v246, v246, v182
    v_add_f32 v246, v246, v183
    v_mfma_f32_16x16x32_bf16 v[144:147], v[192:195], a[200:203], v[144:147]
    v_cvt_pk_bf16_f32 v179, v182, v183
    v_mfma_f32_16x16x32_bf16 v[152:155], v[192:195], a[232:235], v[152:155]
    ds_read_b128 v[192:195], v224 offset:33024
    v_mfma_f32_16x16x32_bf16 v[132:135], v[196:199], a[136:139], v[132:135]
    v_exp_f32 v184, v184
    v_mfma_f32_16x16x32_bf16 v[140:143], v[196:199], a[168:171], v[140:143]
    v_exp_f32 v185, v185
    v_mfma_f32_16x16x32_bf16 v[148:151], v[196:199], a[200:203], v[148:151]
    v_add_f32 v247, v247, v184
    v_add_f32 v247, v247, v185
    v_mfma_f32_16x16x32_bf16 v[156:159], v[196:199], a[232:235], v[156:159]
    ds_read_b128 v[196:199], v224 offset:41216
    s_waitcnt lgkmcnt(2)
    v_mfma_f32_16x16x32_bf16 v[128:131], v[200:203], a[140:143], v[128:131]
    v_exp_f32 v186, v186
    v_mfma_f32_16x16x32_bf16 v[136:139], v[200:203], a[172:175], v[136:139]
    v_cvt_pk_bf16_f32 v184, v184, v185
    v_add_f32 v247, v247, v186
    v_mfma_f32_16x16x32_bf16 v[144:147], v[200:203], a[204:207], v[144:147]
    v_exp_f32 v187, v187
    v_mfma_f32_16x16x32_bf16 v[152:155], v[200:203], a[236:239], v[152:155]
    ds_read_b128 v[200:203], v225 offset:33024
    v_add_f32 v247, v247, v187
    v_mfma_f32_16x16x32_bf16 v[132:135], v[204:207], a[140:143], v[132:135]
    v_exp_f32 v188, v188
    v_mfma_f32_16x16x32_bf16 v[140:143], v[204:207], a[172:175], v[140:143]
    v_cvt_pk_bf16_f32 v185, v186, v187
    v_add_f32 v247, v247, v188
    v_mfma_f32_16x16x32_bf16 v[148:151], v[204:207], a[204:207], v[148:151]
    v_exp_f32 v189, v189
    v_mfma_f32_16x16x32_bf16 v[156:159], v[204:207], a[236:239], v[156:159]
    ds_read_b128 v[204:207], v225 offset:41216
    s_waitcnt lgkmcnt(2)
    v_mfma_f32_16x16x32_bf16 v[128:131], v[192:195], a[144:147], v[128:131]
    v_exp_f32 v190, v190
    v_mfma_f32_16x16x32_bf16 v[136:139], v[192:195], a[176:179], v[136:139]
    v_add_f32 v247, v247, v189
    v_cvt_pk_bf16_f32 v186, v188, v189
    v_mfma_f32_16x16x32_bf16 v[144:147], v[192:195], a[208:211], v[144:147]
    v_exp_f32 v191, v191
    v_mfma_f32_16x16x32_bf16 v[152:155], v[192:195], a[240:243], v[152:155]
    ds_read_b128 v[192:195], v226 offset:33024
    v_add_f32 v247, v247, v190
    v_mfma_f32_16x16x32_bf16 v[132:135], v[196:199], a[144:147], v[132:135]
    v_add_f32 v247, v247, v191
    v_cvt_pk_bf16_f32 v187, v190, v191
    v_mfma_f32_16x16x32_bf16 v[140:143], v[196:199], a[176:179], v[140:143]
    v_mfma_f32_16x16x32_bf16 v[148:151], v[196:199], a[208:211], v[148:151]
    v_mfma_f32_16x16x32_bf16 v[156:159], v[196:199], a[240:243], v[156:159]
    ds_read_b128 v[196:199], v226 offset:41216
    s_waitcnt lgkmcnt(2)
    v_mfma_f32_16x16x32_bf16 v[128:131], v[200:203], a[148:151], v[128:131]
    v_mfma_f32_16x16x32_bf16 v[136:139], v[200:203], a[180:183], v[136:139]
    v_mfma_f32_16x16x32_bf16 v[144:147], v[200:203], a[212:215], v[144:147]
    v_mfma_f32_16x16x32_bf16 v[152:155], v[200:203], a[244:247], v[152:155]
    ds_read_b128 v[200:203], v227 offset:33024
    v_mfma_f32_16x16x32_bf16 v[132:135], v[204:207], a[148:151], v[132:135]
    v_mfma_f32_16x16x32_bf16 v[140:143], v[204:207], a[180:183], v[140:143]
    v_mfma_f32_16x16x32_bf16 v[148:151], v[204:207], a[212:215], v[148:151]
    v_mfma_f32_16x16x32_bf16 v[156:159], v[204:207], a[244:247], v[156:159]
    ds_read_b128 v[204:207], v227 offset:41216
    s_waitcnt lgkmcnt(3)
    v_mfma_f32_16x16x32_bf16 v[128:131], v[192:195], a[152:155], v[128:131]
    v_mfma_f32_16x16x32_bf16 v[136:139], v[192:195], a[184:187], v[136:139]
    v_mfma_f32_16x16x32_bf16 v[144:147], v[192:195], a[216:219], v[144:147]
    v_mfma_f32_16x16x32_bf16 v[152:155], v[192:195], a[248:251], v[152:155]
    s_waitcnt lgkmcnt(0)
    s_waitcnt vmcnt(16)
    s_barrier
    ds_read_b64_tr_b16 v[192:193], v228 offset:16384
    ds_read_b64_tr_b16 v[194:195], v228 offset:24576
    v_mfma_f32_16x16x32_bf16 v[132:135], v[196:199], a[152:155], v[132:135]
    v_mfma_f32_16x16x32_bf16 v[140:143], v[196:199], a[184:187], v[140:143]
    s_add_u32 m0, s27, 32768
    s_nop 0
    buffer_load_dwordx4 v236, s[8:11], s22 offen offset:0 nt lds
    v_mfma_f32_16x16x32_bf16 v[148:151], v[196:199], a[216:219], v[148:151]
    v_mfma_f32_16x16x32_bf16 v[156:159], v[196:199], a[248:251], v[156:159]
    ds_read_b64_tr_b16 v[196:197], v229 offset:16384
    ds_read_b64_tr_b16 v[198:199], v229 offset:24576
    v_mfma_f32_16x16x32_bf16 v[128:131], v[200:203], a[156:159], v[128:131]
    v_mfma_f32_16x16x32_bf16 v[136:139], v[200:203], a[188:191], v[136:139]
    buffer_load_dwordx4 v237, s[8:11], s22 offen offset:1024 nt lds
    v_mfma_f32_16x16x32_bf16 v[144:147], v[200:203], a[220:223], v[144:147]
    v_mfma_f32_16x16x32_bf16 v[152:155], v[200:203], a[252:255], v[152:155]
    ds_read_b64_tr_b16 v[200:201], v230 offset:16384
    ds_read_b64_tr_b16 v[202:203], v230 offset:24576
    v_mfma_f32_16x16x32_bf16 v[132:135], v[204:207], a[156:159], v[132:135]
    v_mfma_f32_16x16x32_bf16 v[140:143], v[204:207], a[188:191], v[140:143]
    buffer_load_dwordx4 v238, s[8:11], s22 offen offset:2048 nt lds
    v_mfma_f32_16x16x32_bf16 v[148:151], v[204:207], a[220:223], v[148:151]
    v_mfma_f32_16x16x32_bf16 v[156:159], v[204:207], a[252:255], v[156:159]
    s_cmp_lg_u32 s25, 0
    s_cbranch_scc1 L_stub_3
L_back_3:
    s_waitcnt lgkmcnt(2)
    v_mfma_f32_16x16x32_bf16 v[0:3], v[192:195], v[160:163], v[0:3]
    ds_read_b64_tr_b16 v[204:205], v231 offset:16384
    ds_read_b64_tr_b16 v[206:207], v231 offset:24576
    v_mfma_f32_16x16x32_bf16 v[64:67], v[192:195], v[168:171], v[64:67]
    buffer_load_dwordx4 v239, s[8:11], s22 offen offset:3072 nt lds
    s_add_u32 s22, s22, 16384
    v_mfma_f32_16x16x32_bf16 a[0:3], v[192:195], v[176:179], a[0:3]
    v_mfma_f32_16x16x32_bf16 a[64:67], v[192:195], v[184:187], a[64:67]
    ds_read_b64_tr_b16 v[192:193], v232 offset:16384
    ds_read_b64_tr_b16 v[194:195], v232 offset:24576
    v_mfma_f32_16x16x32_bf16 v[4:7], v[196:199], v[160:163], v[4:7]
    v_mfma_f32_16x16x32_bf16 v[68:71], v[196:199], v[168:171], v[68:71]
    s_add_u32 m0, s28, 0
    s_nop 0
    buffer_load_dwordx4 v240, s[12:15], s23 offen offset:0 nt lds
    v_mfma_f32_16x16x32_bf16 a[4:7], v[196:199], v[176:179], a[4:7]
    v_max3_f32 v252, v128, v129, v130
    v_max3_f32 v253, v131, v132, v133
    v_mfma_f32_16x16x32_bf16 a[68:71], v[196:199], v[184:187], a[68:71]
    ds_read_b64_tr_b16 v[196:197], v233 offset:16384
    s_waitcnt lgkmcnt(3)
    v_mfma_f32_16x16x32_bf16 v[8:11], v[200:203], v[160:163], v[8:11]
    ds_read_b64_tr_b16 v[198:199], v233 offset:24576
    v_max3_f32 v252, v252, v134, v135
    v_mfma_f32_16x16x32_bf16 v[72:75], v[200:203], v[168:171], v[72:75]
    buffer_load_dwordx4 v241, s[12:15], s23 offen offset:1024 nt lds
    v_mfma_f32_16x16x32_bf16 a[8:11], v[200:203], v[176:179], a[8:11]
    v_max3_f32 v253, v253, v136, v137
    v_max3_f32 v252, v252, v138, v139
    v_mfma_f32_16x16x32_bf16 a[72:75], v[200:203], v[184:187], a[72:75]
    ds_read_b64_tr_b16 v[200:201], v234 offset:16384
    ds_read_b64_tr_b16 v[202:203], v234 offset:24576
    v_mfma_f32_16x16x32_bf16 v[12:15], v[204:207], v[160:163], v[12:15]
    v_max3_f32 v253, v253, v140, v141
    v_max3_f32 v252, v252, v142, v143
    v_mfma_f32_16x16x32_bf16 v[76:79], v[204:207], v[168:171], v[76:79]
    buffer_load_dwordx4 v242, s[12:15], s23 offen offset:2048 nt lds
    v_mfma_f32_16x16x32_bf16 a[12:15], v[204:207], v[176:179], a[12:15]
    v_max3_f32 v253, v253, v144, v145
    v_max3_f32 v252, v252, v146, v147
    v_mfma_f32_16x16x32_bf16 a[76:79], v[204:207], v[184:187], a[76:79]
    ds_read_b64_tr_b16 v[204:205], v235 offset:16384
    s_waitcnt lgkmcnt(3)
    v_mfma_f32_16x16x32_bf16 v[16:19], v[192:195], v[160:163], v[16:19]
    ds_read_b64_tr_b16 v[206:207], v235 offset:24576
    v_max3_f32 v253, v253, v148, v149
    v_mfma_f32_16x16x32_bf16 v[80:83], v[192:195], v[168:171], v[80:83]
    buffer_load_dwordx4 v243, s[12:15], s23 offen offset:3072 nt lds
    s_add_u32 s23, s23, 16384
    v_mfma_f32_16x16x32_bf16 a[16:19], v[192:195], v[176:179], a[16:19]
    v_max3_f32 v252, v252, v150, v151
    v_max3_f32 v253, v253, v152, v153
    v_mfma_f32_16x16x32_bf16 a[80:83], v[192:195], v[184:187], a[80:83]
    ds_read_b64_tr_b16 v[192:193], v228 offset:16640
    ds_read_b64_tr_b16 v[194:195], v228 offset:24832
    v_mfma_f32_16x16x32_bf16 v[20:23], v[196:199], v[160:163], v[20:23]
    v_max3_f32 v252, v252, v154, v155
    v_max3_f32 v253, v253, v156, v157
    v_mfma_f32_16x16x32_bf16 v[84:87], v[196:199], v[168:171], v[84:87]
    v_max3_f32 v252, v252, v158, v159
    v_max_f32 v252, v252, v253
    v_mfma_f32_16x16x32_bf16 a[20:23], v[196:199], v[176:179], a[20:23]
    v_cmp_lt_f32 vcc, s32, v252
    s_cbranch_vccnz L_stub_4
L_back_4:
    v_mfma_f32_16x16x32_bf16 a[84:87], v[196:199], v[184:187], a[84:87]
    ds_read_b64_tr_b16 v[196:197], v229 offset:16640
    s_waitcnt lgkmcnt(3)
    v_mfma_f32_16x16x32_bf16 v[24:27], v[200:203], v[160:163], v[24:27]
    ds_read_b64_tr_b16 v[198:199], v229 offset:24832
    v_mfma_f32_16x16x32_bf16 v[88:91], v[200:203], v[168:171], v[88:91]
    v_exp_f32 v128, v128
    v_mfma_f32_16x16x32_bf16 a[24:27], v[200:203], v[176:179], a[24:27]
    v_exp_f32 v129, v129
    v_mfma_f32_16x16x32_bf16 a[88:91], v[200:203], v[184:187], a[88:91]
    ds_read_b64_tr_b16 v[200:201], v230 offset:16640
    ds_read_b64_tr_b16 v[202:203], v230 offset:24832
    v_mfma_f32_16x16x32_bf16 v[28:31], v[204:207], v[160:163], v[28:31]
    v_add_f32 v244, v244, v128
    v_add_f32 v244, v244, v129
    v_mfma_f32_16x16x32_bf16 v[92:95], v[204:207], v[168:171], v[92:95]
    v_exp_f32 v130, v130
    v_mfma_f32_16x16x32_bf16 a[28:31], v[204:207], v[176:179], a[28:31]
    v_cvt_pk_bf16_f32 v128, v128, v129
    v_add_f32 v244, v244, v130
    v_mfma_f32_16x16x32_bf16 a[92:95], v[204:207], v[184:187], a[92:95]
    ds_read_b64_tr_b16 v[204:205], v231 offset:16640
    s_waitcnt lgkmcnt(3)
    v_mfma_f32_16x16x32_bf16 v[32:35], v[192:195], v[160:163], v[32:35]
    ds_read_b64_tr_b16 v[206:207], v231 offset:24832
    v_mfma_f32_16x16x32_bf16 v[96:99], v[192:195], v[168:171], v[96:99]
    v_exp_f32 v131, v131
    v_mfma_f32_16x16x32_bf16 a[32:35], v[192:195], v[176:179], a[32:35]
    v_exp_f32 v132, v132
    v_mfma_f32_16x16x32_bf16 a[96:99], v[192:195], v[184:187], a[96:99]
    ds_read_b64_tr_b16 v[192:193], v232 offset:16640
    ds_read_b64_tr_b16 v[194:195], v232 offset:24832
    v_mfma_f32_16x16x32_bf16 v[36:39], v[196:199], v[160:163], v[36:39]
    v_add_f32 v244, v244, v131
    v_cvt_pk_bf16_f32 v129, v130, v131
    v_mfma_f32_16x16x32_bf16 v[100:103], v[196:199], v[168:171], v[100:103]
    v_exp_f32 v133, v133
    v_mfma_f32_16x16x32_bf16 a[36:39], v[196:199], v[176:179], a[36:39]
    v_add_f32 v244, v244, v132
    v_add_f32 v244, v244, v133
    v_mfma_f32_16x16x32_bf16 a[100:103], v[196:199], v[184:187], a[100:103]
    ds_read_b64_tr_b16 v[196:197], v233 offset:16640
    s_waitcnt lgkmcnt(3)
    v_mfma_f32_16x16x32_bf16 v[40:43], v[200:203], v[160:163], v[40:43]
    ds_read_b64_tr_b16 v[198:199], v233 offset:24832
    v_cvt_pk_bf16_f32 v130, v132, v133
    v_mfma_f32_16x16x32_bf16 v[104:107], v[200:203], v[168:171], v[104:107]
    v_exp_f32 v134, v134
    v_mfma_f32_16x16x32_bf16 a[40:43], v[200:203], v[176:179], a[40:43]
    v_exp_f32 v135, v135
    v_mfma_f32_16x16x32_bf16 a[104:107], v[200:203], v[184:187], a[104:107]
    ds_read_b64_tr_b16 v[200:201], v234 offset:16640
    ds_read_b64_tr_b16 v[202:203], v234 offset:24832
    v_mfma_f32_16x16x32_bf16 v[44:47], v[204:207], v[160:163], v[44:47]
    v_add_f32 v244, v244, v134
    v_add_f32 v244, v244, v135
    v_mfma_f32_16x16x32_bf16 v[108:111], v[204:207], v[168:171], v[108:111]
    v_cvt_pk_bf16_f32 v131, v134, v135
    v_mfma_f32_16x16x32_bf16 a[44:47], v[204:207], v[176:179], a[44:47]
    v_exp_f32 v136, v136
    v_mfma_f32_16x16x32_bf16 a[108:111], v[204:207], v[184:187], a[108:111]
    ds_read_b64_tr_b16 v[204:205], v235 offset:16640
    s_waitcnt lgkmcnt(3)
    v_mfma_f32_16x16x32_bf16 v[48:51], v[192:195], v[160:163], v[48:51]
    ds_read_b64_tr_b16 v[206:207], v235 offset:24832
    v_add_f32 v245, v245, v136
    v_mfma_f32_16x16x32_bf16 v[112:115], v[192:195], v[168:171], v[112:115]
    v_exp_f32 v137, v137
    v_mfma_f32_16x16x32_bf16 a[48:51], v[192:195], v[176:179], a[48:51]
    v_exp_f32 v138, v138
    v_mfma_f32_16x16x32_bf16 a[112:115], v[192:195], v[184:187], a[112:115]
    ds_read_b128 v[192:195], v224 offset:49152
    v_add_f32 v245, v245, v137
    v_mfma_f32_16x16x32_bf16 v[52:55], v[196:199], v[160:163], v[52:55]
    v_cvt_pk_bf16_f32 v136, v136, v137
    v_add_f32 v245, v245, v138
    v_mfma_f32_16x16x32_bf16 v[116:119], v[196:199], v[168:171], v[116:119]
    v_exp_f32 v139, v139
    v_mfma_f32_16x16x32_bf16 a[52:55], v[196:199], v[176:179], a[52:55]
    v_exp_f32 v140, v140
    v_mfma_f32_16x16x32_bf16 a[116:119], v[196:199], v[184:187], a[116:119]
    ds_read_b128 v[196:199], v224 offset:57344
    s_waitcnt lgkmcnt(2)
    v_mfma_f32_16x16x32_bf16 v[56:59], v[200:203], v[160:163], v[56:59]
    v_add_f32 v245, v245, v139
    v_cvt_pk_bf16_f32 v137, v138, v139
    v_mfma_f32_16x16x32_bf16 v[120:123], v[200:203], v[168:171], v[120:123]
    v_exp_f32 v141, v141
    v_mfma_f32_16x16x32_bf16 a[56:59], v[200:203], v[176:179], a[56:59]
    v_add_f32 v245, v245, v140
    v_add_f32 v245, v245, v141
    v_mfma_f32_16x16x32_bf16 a[120:123], v[200:203], v[184:187], a[120:123]
    ds_read_b128 v[200:203], v225 offset:49152
    v_cvt_pk_bf16_f32 v138, v140, v141
    v_mfma_f32_16x16x32_bf16 v[60:63], v[204:207], v[160:163], v[60:63]
    v_exp_f32 v142, v142
    v_mfma_f32_16x16x32_bf16 v[124:127], v[204:207], v[168:171], v[124:127]
    v_exp_f32 v143, v143
    v_mfma_f32_16x16x32_bf16 a[60:63], v[204:207], v[176:179], a[60:63]
    v_add_f32 v245, v245, v142
    v_add_f32 v245, v245, v143
    v_mfma_f32_16x16x32_bf16 a[124:127], v[204:207], v[184:187], a[124:127]
    ds_read_b128 v[204:207], v225 offset:57344
    s_waitcnt lgkmcnt(2)
    v_mfma_f32_16x16x32_bf16 v[160:163], v[192:195], a[128:131], v[208:211]
    v_cvt_pk_bf16_f32 v139, v142, v143
    v_mfma_f32_16x16x32_bf16 v[168:171], v[192:195], a[160:163], v[212:215]
    v_exp_f32 v144, v144
    v_mfma_f32_16x16x32_bf16 v[176:179], v[192:195], a[192:195], v[216:219]
    v_exp_f32 v145, v145
    v_mfma_f32_16x16x32_bf16 v[184:187], v[192:195], a[224:227], v[220:223]
    ds_read_b128 v[192:195], v226 offset:49152
    v_add_f32 v246, v246, v144
    v_mfma_f32_16x16x32_bf16 v[164:167], v[196:199], a[128:131], v[208:211]
    v_exp_f32 v146, v146
    v_mfma_f32_16x16x32_bf16 v[172:175], v[196:199], a[160:163], v[212:215]
    v_add_f32 v246, v246, v145
    v_cvt_pk_bf16_f32 v144, v144, v145
    v_mfma_f32_16x16x32_bf16 v[180:183], v[196:199], a[192:195], v[216:219]
    v_exp_f32 v147, v147
    v_mfma_f32_16x16x32_bf16 v[188:191], v[196:199], a[224:227], v[220:223]
    ds_read_b128 v[196:199], v226 offset:57344
    s_waitcnt lgkmcnt(2)
    v_mfma_f32_16x16x32_bf16 v[160:163], v[200:203], a[132:135], v[160:163]
    v_add_f32 v246, v246, v146
    v_add_f32 v246, v246, v147
    v_mfma_f32_16x16x32_bf16 v[168:171], v[200:203], a[164:167], v[168:171]
    v_exp_f32 v148, v148
    v_mfma_f32_16x16x32_bf16 v[176:179], v[200:203], a[196:199], v[176:179]
    v_cvt_pk_bf16_f32 v145, v146, v147
    v_add_f32 v246, v246, v148
    v_mfma_f32_16x16x32_bf16 v[184:187], v[200:203], a[228:231], v[184:187]
    ds_read_b128 v[200:203], v227 offset:49152
    v_mfma_f32_16x16x32_bf16 v[164:167], v[204:207], a[132:135], v[164:167]
    v_exp_f32 v149, v149
    v_mfma_f32_16x16x32_bf16 v[172:175], v[204:207], a[164:167], v[172:175]
    v_exp_f32 v150, v150
    v_mfma_f32_16x16x32_bf16 v[180:183], v[204:207], a[196:199], v[180:183]
    v_add_f32 v246, v246, v149
    v_cvt_pk_bf16_f32 v146, v148, v149
    v_mfma_f32_16x16x32_bf16 v[188:191], v[204:207], a[228:231], v[188:191]
    ds_read_b128 v[204:207], v227 offset:57344
    s_waitcnt lgkmcnt(2)
    v_mfma_f32_16x16x32_bf16 v[160:163], v[192:195], a[136:139], v[160:163]
    v_exp_f32 v151, v151
    v_mfma_f32_16x16x32_bf16 v[168:171], v[192:195], a[168:171], v[168:171]
    v_add_f32 v246, v246, v150
    v_add_f32 v246, v246, v151
    v_mfma_f32_16x16x32_bf16 v[176:179], v[192:195], a[200:203], v[176:179]
    v_cvt_pk_bf16_f32 v147, v150, v151
    v_mfma_f32_16x16x32_bf16 v[184:187], v[192:195], a[232:235], v[184:187]
    ds_read_b128 v[192:195], v224 offset:49408
    v_mfma_f32_16x16x32_bf16 v[164:167], v[196:199], a[136:139], v[164:167]
    v_exp_f32 v152, v152
    v_mfma_f32_16x16x32_bf16 v[172:175], v[196:199], a[168:171], v[172:175]
    v_exp_f32 v153, v153
    v_mfma_f32_16x16x32_bf16 v[180:183], v[196:199], a[200:203], v[180:183]
    v_add_f32 v247, v247, v152
    v_add_f32 v247, v247, v153
    v_mfma_f32_16x16x32_bf16 v[188:191], v[196:199], a[232:235], v[188:191]
    ds_read_b128 v[196:199], v224 offset:57600
    s_waitcnt lgkmcnt(2)
    v_mfma_f32_16x16x32_bf16 v[160:163], v[200:203], a[140:143], v[160:163]
    v_exp_f32 v154, v154
    v_mfma_f32_16x16x32_bf16 v[168:171], v[200:203], a[172:175], v[168:171]
    v_cvt_pk_bf16_f32 v152, v152, v153
    v_add_f32 v247, v247, v154
    v_mfma_f32_16x16x32_bf16 v[176:179], v[200:203], a[204:207], v[176:179]
    v_exp_f32 v155, v155
    v_mfma_f32_16x16x32_bf16 v[184:187], v[200:203], a[236:239], v[184:187]
    ds_read_b128 v[200:203], v225 offset:49408
    v_add_f32 v247, v247, v155
    v_mfma_f32_16x16x32_bf16 v[164:167], v[204:207], a[140:143], v[164:167]
    v_exp_f32 v156, v156
    v_mfma_f32_16x16x32_bf16 v[172:175], v[204:207], a[172:175], v[172:175]
    v_cvt_pk_bf16_f32 v153, v154, v155
    v_add_f32 v247, v247, v156
    v_mfma_f32_16x16x32_bf16 v[180:183], v[204:207], a[204:207], v[180:183]
    v_exp_f32 v157, v157
    v_mfma_f32_16x16x32_bf16 v[188:191], v[204:207], a[236:239], v[188:191]
    ds_read_b128 v[204:207], v225 offset:57600
    s_waitcnt lgkmcnt(2)
    v_mfma_f32_16x16x32_bf16 v[160:163], v[192:195], a[144:147], v[160:163]
    v_exp_f32 v158, v158
    v_mfma_f32_16x16x32_bf16 v[168:171], v[192:195], a[176:179], v[168:171]
    v_add_f32 v247, v247, v157
    v_cvt_pk_bf16_f32 v154, v156, v157
    v_mfma_f32_16x16x32_bf16 v[176:179], v[192:195], a[208:211], v[176:179]
    v_exp_f32 v159, v159
    v_mfma_f32_16x16x32_bf16 v[184:187], v[192:195], a[240:243], v[184:187]
    ds_read_b128 v[192:195], v226 offset:49408
    v_add_f32 v247, v247, v158
    v_mfma_f32_16x16x32_bf16 v[164:167], v[196:199], a[144:147], v[164:167]
    v_add_f32 v247, v247, v159
    v_cvt_pk_bf16_f32 v155, v158, v159
    v_mfma_f32_16x16x32_bf16 v[172:175], v[196:199], a[176:179], v[172:175]
    v_mfma_f32_16x16x32_bf16 v[180:183], v[196:199], a[208:211], v[180:183]
    v_mfma_f32_16x16x32_bf16 v[188:191], v[196:199], a[240:243], v[188:191]
    ds_read_b128 v[196:199], v226 offset:57600
    s_waitcnt lgkmcnt(2)
    v_mfma_f32_16x16x32_bf16 v[160:163], v[200:203], a[148:151], v[160:163]
    v_mfma_f32_16x16x32_bf16 v[168:171], v[200:203], a[180:183], v[168:171]
    v_mfma_f32_16x16x32_bf16 v[176:179], v[200:203], a[212:215], v[176:179]
    v_mfma_f32_16x16x32_bf16 v[184:187], v[200:203], a[244:247], v[184:187]
    ds_read_b128 v[200:203], v227 offset:49408
    v_mfma_f32_16x16x32_bf16 v[164:167], v[204:207], a[148:151], v[164:167]
    v_mfma_f32_16x16x32_bf16 v[172:175], v[204:207], a[180:183], v[172:175]
    v_mfma_f32_16x16x32_bf16 v[180:183], v[204:207], a[212:215], v[180:183]
    v_mfma_f32_16x16x32_bf16 v[188:191], v[204:207], a[244:247], v[188:191]
    ds_read_b128 v[204:207], v227 offset:57600
    s_waitcnt lgkmcnt(3)
    v_mfma_f32_16x16x32_bf16 v[160:163], v[192:195], a[152:155], v[160:163]
    v_mfma_f32_16x16x32_bf16 v[168:171], v[192:195], a[184:187], v[168:171]
    v_mfma_f32_16x16x32_bf16 v[176:179], v[192:195], a[216:219], v[176:179]
    v_mfma_f32_16x16x32_bf16 v[184:187], v[192:195], a[248:251], v[184:187]
    s_waitcnt lgkmcnt(0)
    s_waitcnt vmcnt(16)
    s_barrier
    ds_read_b64_tr_b16 v[192:193], v228 offset:32768
    ds_read_b64_tr_b16 v[194:195], v228 offset:40960
    v_mfma_f32_16x16x32_bf16 v[164:167], v[196:199], a[152:155], v[164:167]
    v_mfma_f32_16x16x32_bf16 v[172:175], v[196:199], a[184:187], v[172:175]
    s_add_u32 m0, s27, 49152
    s_nop 0
    buffer_load_dwordx4 v236, s[8:11], s22 offen offset:0 nt lds
    v_mfma_f32_16x16x32_bf16 v[180:183], v[196:199], a[216:219], v[180:183]
    v_mfma_f32_16x16x32_bf16 v[188:191], v[196:199], a[248:251], v[188:191]
    ds_read_b64_tr_b16 v[196:197], v229 offset:32768
    ds_read_b64_tr_b16 v[198:199], v229 offset:40960
    v_mfma_f32_16x16x32_bf16 v[160:163], v[200:203], a[156:159], v[160:163]
    v_mfma_f32_16x16x32_bf16 v[168:171], v[200:203], a[188:191], v[168:171]
    buffer_load_dwordx4 v237, s[8:11], s22 offen offset:1024 nt lds
    v_mfma_f32_16x16x32_bf16 v[176:179], v[200:203], a[220:223], v[176:179]
    v_mfma_f32_16x16x32_bf16 v[184:187], v[200:203], a[252:255], v[184:187]
    ds_read_b64_tr_b16 v[200:201], v230 offset:32768
    ds_read_b64_tr_b16 v[202:203], v230 offset:40960
    v_mfma_f32_16x16x32_bf16 v[164:167], v[204:207], a[156:159], v[164:167]
    v_mfma_f32_16x16x32_bf16 v[172:175], v[204:207], a[188:191], v[172:175]
    buffer_load_dwordx4 v238, s[8:11], s22 offen offset:2048 nt lds
    v_mfma_f32_16x16x32_bf16 v[180:183], v[204:207], a[220:223], v[180:183]
    v_mfma_f32_16x16x32_bf16 v[188:191], v[204:207], a[252:255], v[188:191]
    s_cmp_lg_u32 s25, 0
    s_cbranch_scc1 L_stub_5
L_back_5:
    s_waitcnt lgkmcnt(2)
    v_mfma_f32_16x16x32_bf16 v[0:3], v[192:195], v[128:131], v[0:3]
    ds_read_b64_tr_b16 v[204:205], v231 offset:32768
    ds_read_b64_tr_b16 v[206:207], v231 offset:40960
    v_mfma_f32_16x16x32_bf16 v[64:67], v[192:195], v[136:139], v[64:67]
    buffer_load_dwordx4 v239, s[8:11], s22 offen offset:3072 nt lds
    s_add_u32 s22, s22, 16384
    v_mfma_f32_16x16x32_bf16 a[0:3], v[192:195], v[144:147], a[0:3]
    v_mfma_f32_16x16x32_bf16 a[64:67], v[192:195], v[152:155], a[64:67]
    ds_read_b64_tr_b16 v[192:193], v232 offset:32768
    ds_read_b64_tr_b16 v[194:195], v232 offset:40960
    v_mfma_f32_16x16x32_bf16 v[4:7], v[196:199], v[128:131], v[4:7]
    v_mfma_f32_16x16x32_bf16 v[68:71], v[196:199], v[136:139], v[68:71]
    s_add_u32 m0, s28, 16384
    s_nop 0
    buffer_load_dwordx4 v240, s[12:15], s23 offen offset:0 nt lds
    v_mfma_f32_16x16x32_bf16 a[4:7], v[196:199], v[144:147], a[4:7]
    v_max3_f32 v252, v160, v161, v162
    v_max3_f32 v253, v163, v164, v165
    v_mfma_f32_16x16x32_bf16 a[68:71], v[196:199], v[152:155], a[68:71]
    ds_read_b64_tr_b16 v[196:197], v233 offset:32768
    s_waitcnt lgkmcnt(3)
    v_mfma_f32_16x16x32_bf16 v[8:11], v[200:203], v[128:131], v[8:11]
    ds_read_b64_tr_b16 v[198:199], v233 offset:40960
    v_max3_f32 v252, v252, v166, v167
    v_mfma_f32_16x16x32_bf16 v[72:75], v[200:203], v[136:139], v[72:75]
    buffer_load_dwordx4 v241, s[12:15], s23 offen offset:1024 nt lds
    v_mfma_f32_16x16x32_bf16 a[8:11], v[200:203], v[144:147], a[8:11]
    v_max3_f32 v253, v253, v168, v169
    v_max3_f32 v252, v252, v170, v171
    v_mfma_f32_16x16x32_bf16 a[72:75], v[200:203], v[152:155], a[72:75]
    ds_read_b64_tr_b16 v[200:201], v234 offset:32768
    ds_read_b64_tr_b16 v[202:203], v234 offset:40960
    v_mfma_f32_16x16x32_bf16 v[12:15], v[204:207], v[128:131], v[12:15]
    v_max3_f32 v253, v253, v172, v173
    v_max3_f32 v252, v252, v174, v175
    v_mfma_f32_16x16x32_bf16 v[76:79], v[204:207], v[136:139], v[76:79]
    buffer_load_dwordx4 v242, s[12:15], s23 offen offset:2048 nt lds
    v_mfma_f32_16x16x32_bf16 a[12:15], v[204:207], v[144:147], a[12:15]
    v_max3_f32 v253, v253, v176, v177
    v_max3_f32 v252, v252, v178, v179
    v_mfma_f32_16x16x32_bf16 a[76:79], v[204:207], v[152:155], a[76:79]
    ds_read_b64_tr_b16 v[204:205], v235 offset:32768
    s_waitcnt lgkmcnt(3)
    v_mfma_f32_16x16x32_bf16 v[16:19], v[192:195], v[128:131], v[16:19]
    ds_read_b64_tr_b16 v[206:207], v235 offset:40960
    v_max3_f32 v253, v253, v180, v181
    v_mfma_f32_16x16x32_bf16 v[80:83], v[192:195], v[136:139], v[80:83]
    buffer_load_dwordx4 v243, s[12:15], s23 offen offset:3072 nt lds
    s_add_u32 s23, s23, 16384
    v_mfma_f32_16x16x32_bf16 a[16:19], v[192:195], v[144:147], a[16:19]
    v_max3_f32 v252, v252, v182, v183
    v_max3_f32 v253, v253, v184, v185
    v_mfma_f32_16x16x32_bf16 a[80:83], v[192:195], v[152:155], a[80:83]
    ds_read_b64_tr_b16 v[192:193], v228 offset:33024
    ds_read_b64_tr_b16 v[194:195], v228 offset:41216
    v_mfma_f32_16x16x32_bf16 v[20:23], v[196:199], v[128:131], v[20:23]
    v_max3_f32 v252, v252, v186, v187
    v_max3_f32 v253, v253, v188, v189
    v_mfma_f32_16x16x32_bf16 v[84:87], v[196:199], v[136:139], v[84:87]
    v_max3_f32 v252, v252, v190, v191
    v_max_f32 v252, v252, v253
    v_mfma_f32_16x16x32_bf16 a[20:23], v[196:199], v[144:147], a[20:23]
    v_cmp_lt_f32 vcc, s32, v252
    s_cbranch_vccnz L_stub_6
L_back_6:
    v_mfma_f32_16x16x32_bf16 a[84:87], v[196:199], v[152:155], a[84:87]
    ds_read_b64_tr_b16 v[196:197], v229 offset:33024
    s_waitcnt lgkmcnt(3)
    v_mfma_f32_16x16x32_bf16 v[24:27], v[200:203], v[128:131], v[24:27]
    ds_read_b64_tr_b16 v[198:199], v229 offset:41216
    v_mfma_f32_16x16x32_bf16 v[88:91], v[200:203], v[136:139], v[88:91]
    v_exp_f32 v160, v160
    v_mfma_f32_16x16x32_bf16 a[24:27], v[200:203], v[144:147], a[24:27]
    v_exp_f32 v161, v161
    v_mfma_f32_16x16x32_bf16 a[88:91], v[200:203], v[152:155], a[88:91]
    ds_read_b64_tr_b16 v[200:201], v230 offset:33024
    ds_read_b64_tr_b16 v[202:203], v230 offset:41216
    v_mfma_f32_16x16x32_bf16 v[28:31], v[204:207], v[128:131], v[28:31]
    v_add_f32 v244, v244, v160
    v_add_f32 v244, v244, v161
    v_mfma_f32_16x16x32_bf16 v[92:95], v[204:207], v[136:139], v[92:95]
    v_exp_f32 v162, v162
    v_mfma_f32_16x16x32_bf16 a[28:31], v[204:207], v[144:147], a[28:31]
    v_cvt_pk_bf16_f32 v160, v160, v161
    v_add_f32 v244, v244, v162
    v_mfma_f32_16x16x32_bf16 a[92:95], v[204:207], v[152:155], a[92:95]
    ds_read_b64_tr_b16 v[204:205], v231 offset:33024
    s_waitcnt lgkmcnt(3)
    v_mfma_f32_16x16x32_bf16 v[32:35], v[192:195], v[128:131], v[32:35]
    ds_read_b64_tr_b16 v[206:207], v231 offset:41216
    v_mfma_f32_16x16x32_bf16 v[96:99], v[192:195], v[136:139], v[96:99]
    v_exp_f32 v163, v163
    v_mfma_f32_16x16x32_bf16 a[32:35], v[192:195], v[144:147], a[32:35]
    v_exp_f32 v164, v164
    v_mfma_f32_16x16x32_bf16 a[96:99], v[192:195], v[152:155], a[96:99]
    ds_read_b64_tr_b16 v[192:193], v232 offset:33024
    ds_read_b64_tr_b16 v[194:195], v232 offset:41216
    v_mfma_f32_16x16x32_bf16 v[36:39], v[196:199], v[128:131], v[36:39]
    v_add_f32 v244, v244, v163
    v_cvt_pk_bf16_f32 v161, v162, v163
    v_mfma_f32_16x16x32_bf16 v[100:103], v[196:199], v[136:139], v[100:103]
    v_exp_f32 v165, v165
    v_mfma_f32_16x16x32_bf16 a[36:39], v[196:199], v[144:147], a[36:39]
    v_add_f32 v244, v244, v164
    v_add_f32 v244, v244, v165
    v_mfma_f32_16x16x32_bf16 a[100:103], v[196:199], v[152:155], a[100:103]
    ds_read_b64_tr_b16 v[196:197], v233 offset:33024
    s_waitcnt lgkmcnt(3)
    v_mfma_f32_16x16x32_bf16 v[40:43], v[200:203], v[128:131], v[40:43]
    ds_read_b64_tr_b16 v[198:199], v233 offset:41216
    v_cvt_pk_bf16_f32 v162, v164, v165
    v_mfma_f32_16x16x32_bf16 v[104:107], v[200:203], v[136:139], v[104:107]
    v_exp_f32 v166, v166
    v_mfma_f32_16x16x32_bf16 a[40:43], v[200:203], v[144:147], a[40:43]
    v_exp_f32 v167, v167
    v_mfma_f32_16x16x32_bf16 a[104:107], v[200:203], v[152:155], a[104:107]
    ds_read_b64_tr_b16 v[200:201], v234 offset:33024
    ds_read_b64_tr_b16 v[202:203], v234 offset:41216
    v_mfma_f32_16x16x32_bf16 v[44:47], v[204:207], v[128:131], v[44:47]
    v_add_f32 v244, v244, v166
    v_add_f32 v244, v244, v167
    v_mfma_f32_16x16x32_bf16 v[108:111], v[204:207], v[136:139], v[108:111]
    v_cvt_pk_bf16_f32 v163, v166, v167
    v_mfma_f32_16x16x32_bf16 a[44:47], v[204:207], v[144:147], a[44:47]
    v_exp_f32 v168, v168
    v_mfma_f32_16x16x32_bf16 a[108:111], v[204:207], v[152:155], a[108:111]
    ds_read_b64_tr_b16 v[204:205], v235 offset:33024
    s_waitcnt lgkmcnt(3)
    v_mfma_f32_16x16x32_bf16 v[48:51], v[192:195], v[128:131], v[48:51]
    ds_read_b64_tr_b16 v[206:207], v235 offset:41216
    v_add_f32 v245, v245, v168
    v_mfma_f32_16x16x32_bf16 v[112:115], v[192:195], v[136:139], v[112:115]
    v_exp_f32 v169, v169
    v_mfma_f32_16x16x32_bf16 a[48:51], v[192:195], v[144:147], a[48:51]
    v_exp_f32 v170, v170
    v_mfma_f32_16x16x32_bf16 a[112:115], v[192:195], v[152:155], a[112:115]
    ds_read_b128 v[192:195], v224 offset:0
    v_add_f32 v245, v245, v169
    v_mfma_f32_16x16x32_bf16 v[52:55], v[196:199], v[128:131], v[52:55]
    v_cvt_pk_bf16_f32 v168, v168, v169
    v_add_f32 v245, v245, v170
    v_mfma_f32_16x16x32_bf16 v[116:119], v[196:199], v[136:139], v[116:119]
    v_exp_f32 v171, v171
    v_mfma_f32_16x16x32_bf16 a[52:55], v[196:199], v[144:147], a[52:55]
    v_exp_f32 v172, v172
    v_mfma_f32_16x16x32_bf16 a[116:119], v[196:199], v[152:155], a[116:119]
    ds_read_b128 v[196:199], v224 offset:8192
    s_waitcnt lgkmcnt(2)
    v_mfma_f32_16x16x32_bf16 v[56:59], v[200:203], v[128:131], v[56:59]
    v_add_f32 v245, v245, v171
    v_cvt_pk_bf16_f32 v169, v170, v171
    v_mfma_f32_16x16x32_bf16 v[120:123], v[200:203], v[136:139], v[120:123]
    v_exp_f32 v173, v173
    v_mfma_f32_16x16x32_bf16 a[56:59], v[200:203], v[144:147], a[56:59]
    v_add_f32 v245, v245, v172
    v_add_f32 v245, v245, v173
    v_mfma_f32_16x16x32_bf16 a[120:123], v[200:203], v[152:155], a[120:123]
    ds_read_b128 v[200:203], v225 offset:0
    v_cvt_pk_bf16_f32 v170, v172, v173
    v_mfma_f32_16x16x32_bf16 v[60:63], v[204:207], v[128:131], v[60:63]
    v_exp_f32 v174, v174
    v_mfma_f32_16x16x32_bf16 v[124:127], v[204:207], v[136:139], v[124:127]
    v_exp_f32 v175, v175
    v_mfma_f32_16x16x32_bf16 a[60:63], v[204:207], v[144:147], a[60:63]
    v_add_f32 v245, v245, v174
    v_add_f32 v245, v245, v175
    v_mfma_f32_16x16x32_bf16 a[124:127], v[204:207], v[152:155], a[124:127]
    ds_read_b128 v[204:207], v225 offset:8192
    s_waitcnt lgkmcnt(2)
    v_mfma_f32_16x16x32_bf16 v[128:131], v[192:195], a[128:131], v[208:211]
    v_cvt_pk_bf16_f32 v171, v174, v175
    v_mfma_f32_16x16x32_bf16 v[136:139], v[192:195], a[160:163], v[212:215]
    v_exp_f32 v176, v176
    v_mfma_f32_16x16x32_bf16 v[144:147], v[192:195], a[192:195], v[216:219]
    v_exp_f32 v177, v177
    v_mfma_f32_16x16x32_bf16 v[152:155], v[192:195], a[224:227], v[220:223]
    ds_read_b128 v[192:195], v226 offset:0
    v_add_f32 v246, v246, v176
    v_mfma_f32_16x16x32_bf16 v[132:135], v[196:199], a[128:131], v[208:211]
    v_exp_f32 v178, v178
    v_mfma_f32_16x16x32_bf16 v[140:143], v[196:199], a[160:163], v[212:215]
    v_add_f32 v246, v246, v177
    v_cvt_pk_bf16_f32 v176, v176, v177
    v_mfma_f32_16x16x32_bf16 v[148:151], v[196:199], a[192:195], v[216:219]
    v_exp_f32 v179, v179
    v_mfma_f32_16x16x32_bf16 v[156:159], v[196:199], a[224:227], v[220:223]
    ds_read_b128 v[196:199], v226 offset:8192
    s_waitcnt lgkmcnt(2)
    v_mfma_f32_16x16x32_bf16 v[128:131], v[200:203], a[132:135], v[128:131]
    v_add_f32 v246, v246, v178
    v_add_f32 v246, v246, v179
    v_mfma_f32_16x16x32_bf16 v[136:139], v[200:203], a[164:167], v[136:139]
    v_exp_f32 v180, v180
    v_mfma_f32_16x16x32_bf16 v[144:147], v[200:203], a[196:199], v[144:147]
    v_cvt_pk_bf16_f32 v177, v178, v179
    v_add_f32 v246, v246, v180
    v_mfma_f32_16x16x32_bf16 v[152:155], v[200:203], a[228:231], v[152:155]
    ds_read_b128 v[200:203], v227 offset:0
    v_mfma_f32_16x16x32_bf16 v[132:135], v[204:207], a[132:135], v[132:135]
    v_exp_f32 v181, v181
    v_mfma_f32_16x16x32_bf16 v[140:143], v[204:207], a[164:167], v[140:143]
    v_exp_f32 v182, v182
    v_mfma_f32_16x16x32_bf16 v[148:151], v[204:207], a[196:199], v[148:151]
    v_add_f32 v246, v246, v181
    v_cvt_pk_bf16_f32 v178, v180, v181
    v_mfma_f32_16x16x32_bf16 v[156:159], v[204:207], a[228:231], v[156:159]
    ds_read_b128 v[204:207], v227 offset:8192
    s_waitcnt lgkmcnt(2)
    v_mfma_f32_16x16x32_bf16 v[128:131], v[192:195], a[136:139], v[128:131]
    v_exp_f32 v183, v183
    v_mfma_f32_16x16x32_bf16 v[136:139], v[192:195], a[168:171], v[136:139]
    v_add_f32 v246, v246, v182
    v_add_f32 v246, v246, v183
    v_mfma_f32_16x16x32_bf16 v[144:147], v[192:195], a[200:203], v[144:147]
    v_cvt_pk_bf16_f32 v179, v182, v183
    v_mfma_f32_16x16x32_bf16 v[152:155], v[192:195], a[232:235], v[152:155]
    ds_read_b128 v[192:195], v224 offset:256
    v_mfma_f32_16x16x32_bf16 v[132:135], v[196:199], a[136:139], v[132:135]
    v_exp_f32 v184, v184
    v_mfma_f32_16x16x32_bf16 v[140:143], v[196:199], a[168:171], v[140:143]
    v_exp_f32 v185, v185
    v_mfma_f32_16x16x32_bf16 v[148:151], v[196:199], a[200:203], v[148:151]
    v_add_f32 v247, v247, v184
    v_add_f32 v247, v247, v185
    v_mfma_f32_16x16x32_bf16 v[156:159], v[196:199], a[232:235], v[156:159]
    ds_read_b128 v[196:199], v224 offset:8448
    s_waitcnt lgkmcnt(2)
    v_mfma_f32_16x16x32_bf16 v[128:131], v[200:203], a[140:143], v[128:131]
    v_exp_f32 v186, v186
    v_mfma_f32_16x16x32_bf16 v[136:139], v[200:203], a[172:175], v[136:139]
    v_cvt_pk_bf16_f32 v184, v184, v185
    v_add_f32 v247, v247, v186
    v_mfma_f32_16x16x32_bf16 v[144:147], v[200:203], a[204:207], v[144:147]
    v_exp_f32 v187, v187
    v_mfma_f32_16x16x32_bf16 v[152:155], v[200:203], a[236:239], v[152:155]
    ds_read_b128 v[200:203], v225 offset:256
    v_add_f32 v247, v247, v187
    v_mfma_f32_16x16x32_bf16 v[132:135], v[204:207], a[140:143], v[132:135]
    v_exp_f32 v188, v188
    v_mfma_f32_16x16x32_bf16 v[140:143], v[204:207], a[172:175], v[140:143]
    v_cvt_pk_bf16_f32 v185, v186, v187
    v_add_f32 v247, v247, v188
    v_mfma_f32_16x16x32_bf16 v[148:151], v[204:207], a[204:207], v[148:151]
    v_exp_f32 v189, v189
    v_mfma_f32_16x16x32_bf16 v[156:159], v[204:207], a[236:239], v[156:159]
    ds_read_b128 v[204:207], v225 offset:8448
    s_waitcnt lgkmcnt(2)
    v_mfma_f32_16x16x32_bf16 v[128:131], v[192:195], a[144:147], v[128:131]
    v_exp_f32 v190, v190
    v_mfma_f32_16x16x32_bf16 v[136:139], v[192:195], a[176:179], v[136:139]
    v_add_f32 v247, v247, v189
    v_cvt_pk_bf16_f32 v186, v188, v189
    v_mfma_f32_16x16x32_bf16 v[144:147], v[192:195], a[208:211], v[144:147]
    v_exp_f32 v191, v191
    v_mfma_f32_16x16x32_bf16 v[152:155], v[192:195], a[240:243], v[152:155]
    ds_read_b128 v[192:195], v226 offset:256
    v_add_f32 v247, v247, v190
    v_mfma_f32_16x16x32_bf16 v[132:135], v[196:199], a[144:147], v[132:135]
    v_add_f32 v247, v247, v191
    v_cvt_pk_bf16_f32 v187, v190, v191
    v_mfma_f32_16x16x32_bf16 v[140:143], v[196:199], a[176:179], v[140:143]
    v_mfma_f32_16x16x32_bf16 v[148:151], v[196:199], a[208:211], v[148:151]
    v_mfma_f32_16x16x32_bf16 v[156:159], v[196:199], a[240:243], v[156:159]
    ds_read_b128 v[196:199], v226 offset:8448
    s_waitcnt lgkmcnt(2)
    v_mfma_f32_16x16x32_bf16 v[128:131], v[200:203], a[148:151], v[128:131]
    v_mfma_f32_16x16x32_bf16 v[136:139], v[200:203], a[180:183], v[136:139]
    v_mfma_f32_16x16x32_bf16 v[144:147], v[200:203], a[212:215], v[144:147]
    v_mfma_f32_16x16x32_bf16 v[152:155], v[200:203], a[244:247], v[152:155]
    ds_read_b128 v[200:203], v227 offset:256
    v_mfma_f32_16x16x32_bf16 v[132:135], v[204:207], a[148:151], v[132:135]
    v_mfma_f32_16x16x32_bf16 v[140:143], v[204:207], a[180:183], v[140:143]
    v_mfma_f32_16x16x32_bf16 v[148:151], v[204:207], a[212:215], v[148:151]
    v_mfma_f32_16x16x32_bf16 v[156:159], v[204:207], a[244:247], v[156:159]
    ds_read_b128 v[204:207], v227 offset:8448
    s_waitcnt lgkmcnt(3)
    v_mfma_f32_16x16x32_bf16 v[128:131], v[192:195], a[152:155], v[128:131]
    v_mfma_f32_16x16x32_bf16 v[136:139], v[192:195], a[184:187], v[136:139]
    v_mfma_f32_16x16x32_bf16 v[144:147], v[192:195], a[216:219], v[144:147]
    v_mfma_f32_16x16x32_bf16 v[152:155], v[192:195], a[248:251], v[152:155]
    s_waitcnt lgkmcnt(0)
    s_waitcnt vmcnt(16)
    s_barrier
    ds_read_b64_tr_b16 v[192:193], v228 offset:49152
    ds_read_b64_tr_b16 v[194:195], v228 offset:57344
    v_mfma_f32_16x16x32_bf16 v[132:135], v[196:199], a[152:155], v[132:135]
    v_mfma_f32_16x16x32_bf16 v[140:143], v[196:199], a[184:187], v[140:143]
    s_add_u32 m0, s27, 0
    s_nop 0
    buffer_load_dwordx4 v236, s[8:11], s22 offen offset:0 nt lds
    v_mfma_f32_16x16x32_bf16 v[148:151], v[196:199], a[216:219], v[148:151]
    v_mfma_f32_16x16x32_bf16 v[156:159], v[196:199], a[248:251], v[156:159]
    ds_read_b64_tr_b16 v[196:197], v229 offset:49152
    ds_read_b64_tr_b16 v[198:199], v229 offset:57344
    v_mfma_f32_16x16x32_bf16 v[128:131], v[200:203], a[156:159], v[128:131]
    v_mfma_f32_16x16x32_bf16 v[136:139], v[200:203], a[188:191], v[136:139]
    buffer_load_dwordx4 v237, s[8:11], s22 offen offset:1024 nt lds
    v_mfma_f32_16x16x32_bf16 v[144:147], v[200:203], a[220:223], v[144:147]
    v_mfma_f32_16x16x32_bf16 v[152:155], v[200:203], a[252:255], v[152:155]
    ds_read_b64_tr_b16 v[200:201], v230 offset:49152
    ds_read_b64_tr_b16 v[202:203], v230 offset:57344
    v_mfma_f32_16x16x32_bf16 v[132:135], v[204:207], a[156:159], v[132:135]
    v_mfma_f32_16x16x32_bf16 v[140:143], v[204:207], a[188:191], v[140:143]
    buffer_load_dwordx4 v238, s[8:11], s22 offen offset:2048 nt lds
    v_mfma_f32_16x16x32_bf16 v[148:151], v[204:207], a[220:223], v[148:151]
    v_mfma_f32_16x16x32_bf16 v[156:159], v[204:207], a[252:255], v[156:159]
    s_cmp_lg_u32 s25, 0
    s_cbranch_scc1 L_stub_7
L_back_7:
    s_waitcnt lgkmcnt(2)
    v_mfma_f32_16x16x32_bf16 v[0:3], v[192:195], v[160:163], v[0:3]
    ds_read_b64_tr_b16 v[204:205], v231 offset:49152
    ds_read_b64_tr_b16 v[206:207], v231 offset:57344
    v_mfma_f32_16x16x32_bf16 v[64:67], v[192:195], v[168:171], v[64:67]
    buffer_load_dwordx4 v239, s[8:11], s22 offen offset:3072 nt lds
    s_add_u32 s22, s22, 16384
    v_mfma_f32_16x16x32_bf16 a[0:3], v[192:195], v[176:179], a[0:3]
    v_mfma_f32_16x16x32_bf16 a[64:67], v[192:195], v[184:187], a[64:67]
    ds_read_b64_tr_b16 v[192:193], v232 offset:49152
    ds_read_b64_tr_b16 v[194:195], v232 offset:57344
    v_mfma_f32_16x16x32_bf16 v[4:7], v[196:199], v[160:163], v[4:7]
    v_mfma_f32_16x16x32_bf16 v[68:71], v[196:199], v[168:171], v[68:71]
    s_add_u32 m0, s28, 32768
    s_nop 0
    buffer_load_dwordx4 v240, s[12:15], s23 offen offset:0 nt lds
    v_mfma_f32_16x16x32_bf16 a[4:7], v[196:199], v[176:179], a[4:7]
    v_max3_f32 v252, v128, v129, v130
    v_max3_f32 v253, v131, v132, v133
    v_mfma_f32_16x16x32_bf16 a[68:71], v[196:199], v[184:187], a[68:71]
    ds_read_b64_tr_b16 v[196:197], v233 offset:49152
    s_waitcnt lgkmcnt(3)
    v_mfma_f32_16x16x32_bf16 v[8:11], v[200:203], v[160:163], v[8:11]
    ds_read_b64_tr_b16 v[198:199], v233 offset:57344
    v_max3_f32 v252, v252, v134, v135
    v_mfma_f32_16x16x32_bf16 v[72:75], v[200:203], v[168:171], v[72:75]
    buffer_load_dwordx4 v241, s[12:15], s23 offen offset:1024 nt lds
    v_mfma_f32_16x16x32_bf16 a[8:11], v[200:203], v[176:179], a[8:11]
    v_max3_f32 v253, v253, v136, v137
    v_max3_f32 v252, v252, v138, v139
    v_mfma_f32_16x16x32_bf16 a[72:75], v[200:203], v[184:187], a[72:75]
    ds_read_b64_tr_b16 v[200:201], v234 offset:49152
    ds_read_b64_tr_b16 v[202:203], v234 offset:57344
    v_mfma_f32_16x16x32_bf16 v[12:15], v[204:207], v[160:163], v[12:15]
    v_max3_f32 v253, v253, v140, v141
    v_max3_f32 v252, v252, v142, v143
    v_mfma_f32_16x16x32_bf16 v[76:79], v[204:207], v[168:171], v[76:79]
    buffer_load_dwordx4 v242, s[12:15], s23 offen offset:2048 nt lds
    v_mfma_f32_16x16x32_bf16 a[12:15], v[204:207], v[176:179], a[12:15]
    v_max3_f32 v253, v253, v144, v145
    v_max3_f32 v252, v252, v146, v147
    v_mfma_f32_16x16x32_bf16 a[76:79], v[204:207], v[184:187], a[76:79]
    ds_read_b64_tr_b16 v[204:205], v235 offset:49152
    s_waitcnt lgkmcnt(3)
    v_mfma_f32_16x16x32_bf16 v[16:19], v[192:195], v[160:163], v[16:19]
    ds_read_b64_tr_b16 v[206:207], v235 offset:57344
    v_max3_f32 v253, v253, v148, v149
    v_mfma_f32_16x16x32_bf16 v[80:83], v[192:195], v[168:171], v[80:83]
    buffer_load_dwordx4 v243, s[12:15], s23 offen offset:3072 nt lds
    s_add_u32 s23, s23, 16384
    v_mfma_f32_16x16x32_bf16 a[16:19], v[192:195], v[176:179], a[16:19]
    v_max3_f32 v252, v252, v150, v151
    v_max3_f32 v253, v253, v152, v153
    v_mfma_f32_16x16x32_bf16 a[80:83], v[192:195], v[184:187], a[80:83]
    ds_read_b64_tr_b16 v[192:193], v228 offset:49408
    ds_read_b64_tr_b16 v[194:195], v228 offset:57600
    v_mfma_f32_16x16x32_bf16 v[20:23], v[196:199], v[160:163], v[20:23]
    v_max3_f32 v252, v252, v154, v155
    v_max3_f32 v253, v253, v156, v157
    v_mfma_f32_16x16x32_bf16 v[84:87], v[196:199], v[168:171], v[84:87]
    v_max3_f32 v252, v252, v158, v159
    v_max_f32 v252, v252, v253
    v_mfma_f32_16x16x32_bf16 a[20:23], v[196:199], v[176:179], a[20:23]
    v_cmp_lt_f32 vcc, s32, v252
    s_cbranch_vccnz L_stub_8
L_back_8:
    v_mfma_f32_16x16x32_bf16 a[84:87], v[196:199], v[184:187], a[84:87]
    ds_read_b64_tr_b16 v[196:197], v229 offset:49408
    s_waitcnt lgkmcnt(3)
    v_mfma_f32_16x16x32_bf16 v[24:27], v[200:203], v[160:163], v[24:27]
    ds_read_b64_tr_b16 v[198:199], v229 offset:57600
    v_mfma_f32_16x16x32_bf16 v[88:91], v[200:203], v[168:171], v[88:91]
    v_exp_f32 v128, v128
    v_mfma_f32_16x16x32_bf16 a[24:27], v[200:203], v[176:179], a[24:27]
    v_exp_f32 v129, v129
    v_mfma_f32_16x16x32_bf16 a[88:91], v[200:203], v[184:187], a[88:91]
    ds_read_b64_tr_b16 v[200:201], v230 offset:49408
    ds_read_b64_tr_b16 v[202:203], v230 offset:57600
    v_mfma_f32_16x16x32_bf16 v[28:31], v[204:207], v[160:163], v[28:31]
    v_add_f32 v244, v244, v128
    v_add_f32 v244, v244, v129
    v_mfma_f32_16x16x32_bf16 v[92:95], v[204:207], v[168:171], v[92:95]
    v_exp_f32 v130, v130
    v_mfma_f32_16x16x32_bf16 a[28:31], v[204:207], v[176:179], a[28:31]
    v_cvt_pk_bf16_f32 v128, v128, v129
    v_add_f32 v244, v244, v130
    v_mfma_f32_16x16x32_bf16 a[92:95], v[204:207], v[184:187], a[92:95]
    ds_read_b64_tr_b16 v[204:205], v231 offset:49408
    s_waitcnt lgkmcnt(3)
    v_mfma_f32_16x16x32_bf16 v[32:35], v[192:195], v[160:163], v[32:35]
    ds_read_b64_tr_b16 v[206:207], v231 offset:57600
    v_mfma_f32_16x16x32_bf16 v[96:99], v[192:195], v[168:171], v[96:99]
    v_exp_f32 v131, v131
    v_mfma_f32_16x16x32_bf16 a[32:35], v[192:195], v[176:179], a[32:35]
    v_exp_f32 v132, v132
    v_mfma_f32_16x16x32_bf16 a[96:99], v[192:195], v[184:187], a[96:99]
    ds_read_b64_tr_b16 v[192:193], v232 offset:49408
    ds_read_b64_tr_b16 v[194:195], v232 offset:57600
    v_mfma_f32_16x16x32_bf16 v[36:39], v[196:199], v[160:163], v[36:39]
    v_add_f32 v244, v244, v131
    v_cvt_pk_bf16_f32 v129, v130, v131
    v_mfma_f32_16x16x32_bf16 v[100:103], v[196:199], v[168:171], v[100:103]
    v_exp_f32 v133, v133
    v_mfma_f32_16x16x32_bf16 a[36:39], v[196:199], v[176:179], a[36:39]
    v_add_f32 v244, v244, v132
    v_add_f32 v244, v244, v133
    v_mfma_f32_16x16x32_bf16 a[100:103], v[196:199], v[184:187], a[100:103]
    ds_read_b64_tr_b16 v[196:197], v233 offset:49408
    s_waitcnt lgkmcnt(3)
    v_mfma_f32_16x16x32_bf16 v[40:43], v[200:203], v[160:163], v[40:43]
    ds_read_b64_tr_b16 v[198:199], v233 offset:57600
    v_cvt_pk_bf16_f32 v130, v132, v133
    v_mfma_f32_16x16x32_bf16 v[104:107], v[200:203], v[168:171], v[104:107]
    v_exp_f32 v134, v134
    v_mfma_f32_16x16x32_bf16 a[40:43], v[200:203], v[176:179], a[40:43]
    v_exp_f32 v135, v135
    v_mfma_f32_16x16x32_bf16 a[104:107], v[200:203], v[184:187], a[104:107]
    ds_read_b64_tr_b16 v[200:201], v234 offset:49408
    ds_read_b64_tr_b16 v[202:203], v234 offset:57600
    v_mfma_f32_16x16x32_bf16 v[44:47], v[204:207], v[160:163], v[44:47]
    v_add_f32 v244, v244, v134
    v_add_f32 v244, v244, v135
    v_mfma_f32_16x16x32_bf16 v[108:111], v[204:207], v[168:171], v[108:111]
    v_cvt_pk_bf16_f32 v131, v134, v135
    v_mfma_f32_16x16x32_bf16 a[44:47], v[204:207], v[176:179], a[44:47]
    v_exp_f32 v136, v136
    v_mfma_f32_16x16x32_bf16 a[108:111], v[204:207], v[184:187], a[108:111]
    ds_read_b64_tr_b16 v[204:205], v235 offset:49408
    s_waitcnt lgkmcnt(3)
    v_mfma_f32_16x16x32_bf16 v[48:51], v[192:195], v[160:163], v[48:51]
    ds_read_b64_tr_b16 v[206:207], v235 offset:57600
    v_add_f32 v245, v245, v136
    v_mfma_f32_16x16x32_bf16 v[112:115], v[192:195], v[168:171], v[112:115]
    v_exp_f32 v137, v137
    v_mfma_f32_16x16x32_bf16 a[48:51], v[192:195], v[176:179], a[48:51]
    v_exp_f32 v138, v138
    v_mfma_f32_16x16x32_bf16 a[112:115], v[192:195], v[184:187], a[112:115]
    ds_read_b128 v[192:195], v224 offset:16384
    v_add_f32 v245, v245, v137
    v_mfma_f32_16x16x32_bf16 v[52:55], v[196:199], v[160:163], v[52:55]
    v_cvt_pk_bf16_f32 v136, v136, v137
    v_add_f32 v245, v245, v138
    v_mfma_f32_16x16x32_bf16 v[116:119], v[196:199], v[168:171], v[116:119]
    v_exp_f32 v139, v139
    v_mfma_f32_16x16x32_bf16 a[52:55], v[196:199], v[176:179], a[52:55]
    v_exp_f32 v140, v140
    v_mfma_f32_16x16x32_bf16 a[116:119], v[196:199], v[184:187], a[116:119]
    ds_read_b128 v[196:199], v224 offset:24576
    s_waitcnt lgkmcnt(2)
    v_mfma_f32_16x16x32_bf16 v[56:59], v[200:203], v[160:163], v[56:59]
    v_add_f32 v245, v245, v139
    v_cvt_pk_bf16_f32 v137, v138, v139
    v_mfma_f32_16x16x32_bf16 v[120:123], v[200:203], v[168:171], v[120:123]
    v_exp_f32 v141, v141
    v_mfma_f32_16x16x32_bf16 a[56:59], v[200:203], v[176:179], a[56:59]
    v_add_f32 v245, v245, v140
    v_add_f32 v245, v245, v141
    v_mfma_f32_16x16x32_bf16 a[120:123], v[200:203], v[184:187], a[120:123]
    ds_read_b128 v[200:203], v225 offset:16384
    v_cvt_pk_bf16_f32 v138, v140, v141
    v_mfma_f32_16x16x32_bf16 v[60:63], v[204:207], v[160:163], v[60:63]
    v_exp_f32 v142, v142
    v_mfma_f32_16x16x32_bf16 v[124:127], v[204:207], v[168:171], v[124:127]
    v_exp_f32 v143, v143
    v_mfma_f32_16x16x32_bf16 a[60:63], v[204:207], v[176:179], a[60:63]
    v_add_f32 v245, v245, v142
    v_add_f32 v245, v245, v143
    v_mfma_f32_16x16x32_bf16 a[124:127], v[204:207], v[184:187], a[124:127]
    ds_read_b128 v[204:207], v225 offset:24576
    s_waitcnt lgkmcnt(2)
    v_mfma_f32_16x16x32_bf16 v[160:163], v[192:195], a[128:131], v[208:211]
    v_cvt_pk_bf16_f32 v139, v142, v143
    v_mfma_f32_16x16x32_bf16 v[168:171], v[192:195], a[160:163], v[212:215]
    v_exp_f32 v144, v144
    v_mfma_f32_16x16x32_bf16 v[176:179], v[192:195], a[192:195], v[216:219]
    v_exp_f32 v145, v145
    v_mfma_f32_16x16x32_bf16 v[184:187], v[192:195], a[224:227], v[220:223]
    ds_read_b128 v[192:195], v226 offset:16384
    v_add_f32 v246, v246, v144
    v_mfma_f32_16x16x32_bf16 v[164:167], v[196:199], a[128:131], v[208:211]
    v_exp_f32 v146, v146
    v_mfma_f32_16x16x32_bf16 v[172:175], v[196:199], a[160:163], v[212:215]
    v_add_f32 v246, v246, v145
    v_cvt_pk_bf16_f32 v144, v144, v145
    v_mfma_f32_16x16x32_bf16 v[180:183], v[196:199], a[192:195], v[216:219]
    v_exp_f32 v147, v147
    v_mfma_f32_16x16x32_bf16 v[188:191], v[196:199], a[224:227], v[220:223]
    ds_read_b128 v[196:199], v226 offset:24576
    s_waitcnt lgkmcnt(2)
    v_mfma_f32_16x16x32_bf16 v[160:163], v[200:203], a[132:135], v[160:163]
    v_add_f32 v246, v246, v146
    v_add_f32 v246, v246, v147
    v_mfma_f32_16x16x32_bf16 v[168:171], v[200:203], a[164:167], v[168:171]
    v_exp_f32 v148, v148
    v_mfma_f32_16x16x32_bf16 v[176:179], v[200:203], a[196:199], v[176:179]
    v_cvt_pk_bf16_f32 v145, v146, v147
    v_add_f32 v246, v246, v148
    v_mfma_f32_16x16x32_bf16 v[184:187], v[200:203], a[228:231], v[184:187]
    ds_read_b128 v[200:203], v227 offset:16384
    v_mfma_f32_16x16x32_bf16 v[164:167], v[204:207], a[132:135], v[164:167]
    v_exp_f32 v149, v149
    v_mfma_f32_16x16x32_bf16 v[172:175], v[204:207], a[164:167], v[172:175]
    v_exp_f32 v150, v150
    v_mfma_f32_16x16x32_bf16 v[180:183], v[204:207], a[196:199], v[180:183]
    v_add_f32 v246, v246, v149
    v_cvt_pk_bf16_f32 v146, v148, v149
    v_mfma_f32_16x16x32_bf16 v[188:191], v[204:207], a[228:231], v[188:191]
    ds_read_b128 v[204:207], v227 offset:24576
    s_waitcnt lgkmcnt(2)
    v_mfma_f32_16x16x32_bf16 v[160:163], v[192:195], a[136:139], v[160:163]
    v_exp_f32 v151, v151
    v_mfma_f32_16x16x32_bf16 v[168:171], v[192:195], a[168:171], v[168:171]
    v_add_f32 v246, v246, v150
    v_add_f32 v246, v246, v151
    v_mfma_f32_16x16x32_bf16 v[176:179], v[192:195], a[200:203], v[176:179]
    v_cvt_pk_bf16_f32 v147, v150, v151
    v_mfma_f32_16x16x32_bf16 v[184:187], v[192:195], a[232:235], v[184:187]
    ds_read_b128 v[192:195], v224 offset:16640
    v_mfma_f32_16x16x32_bf16 v[164:167], v[196:199], a[136:139], v[164:167]
    v_exp_f32 v152, v152
    v_mfma_f32_16x16x32_bf16 v[172:175], v[196:199], a[168:171], v[172:175]
    v_exp_f32 v153, v153
    v_mfma_f32_16x16x32_bf16 v[180:183], v[196:199], a[200:203], v[180:183]
    v_add_f32 v247, v247, v152
    v_add_f32 v247, v247, v153
    v_mfma_f32_16x16x32_bf16 v[188:191], v[196:199], a[232:235], v[188:191]
    ds_read_b128 v[196:199], v224 offset:24832
    s_waitcnt lgkmcnt(2)
    v_mfma_f32_16x16x32_bf16 v[160:163], v[200:203], a[140:143], v[160:163]
    v_exp_f32 v154, v154
    v_mfma_f32_16x16x32_bf16 v[168:171], v[200:203], a[172:175], v[168:171]
    v_cvt_pk_bf16_f32 v152, v152, v153
    v_add_f32 v247, v247, v154
    v_mfma_f32_16x16x32_bf16 v[176:179], v[200:203], a[204:207], v[176:179]
    v_exp_f32 v155, v155
    v_mfma_f32_16x16x32_bf16 v[184:187], v[200:203], a[236:239], v[184:187]
    ds_read_b128 v[200:203], v225 offset:16640
    v_add_f32 v247, v247, v155
    v_mfma_f32_16x16x32_bf16 v[164:167], v[204:207], a[140:143], v[164:167]
    v_exp_f32 v156, v156
    v_mfma_f32_16x16x32_bf16 v[172:175], v[204:207], a[172:175], v[172:175]
    v_cvt_pk_bf16_f32 v153, v154, v155
    v_add_f32 v247, v247, v156
    v_mfma_f32_16x16x32_bf16 v[180:183], v[204:207], a[204:207], v[180:183]
    v_exp_f32 v157, v157
    v_mfma_f32_16x16x32_bf16 v[188:191], v[204:207], a[236:239], v[188:191]
    ds_read_b128 v[204:207], v225 offset:24832
    s_waitcnt lgkmcnt(2)
    v_mfma_f32_16x16x32_bf16 v[160:163], v[192:195], a[144:147], v[160:163]
    v_exp_f32 v158, v158
    v_mfma_f32_16x16x32_bf16 v[168:171], v[192:195], a[176:179], v[168:171]
    v_add_f32 v247, v247, v157
    v_cvt_pk_bf16_f32 v154, v156, v157
    v_mfma_f32_16x16x32_bf16 v[176:179], v[192:195], a[208:211], v[176:179]
    v_exp_f32 v159, v159
    v_mfma_f32_16x16x32_bf16 v[184:187], v[192:195], a[240:243], v[184:187]
    ds_read_b128 v[192:195], v226 offset:16640
    v_add_f32 v247, v247, v158
    v_mfma_f32_16x16x32_bf16 v[164:167], v[196:199], a[144:147], v[164:167]
    v_add_f32 v247, v247, v159
    v_cvt_pk_bf16_f32 v155, v158, v159
    v_mfma_f32_16x16x32_bf16 v[172:175], v[196:199], a[176:179], v[172:175]
    v_mfma_f32_16x16x32_bf16 v[180:183], v[196:199], a[208:211], v[180:183]
    v_mfma_f32_16x16x32_bf16 v[188:191], v[196:199], a[240:243], v[188:191]
    ds_read_b128 v[196:199], v226 offset:24832
    s_waitcnt lgkmcnt(2)
    v_mfma_f32_16x16x32_bf16 v[160:163], v[200:203], a[148:151], v[160:163]
    v_mfma_f32_16x16x32_bf16 v[168:171], v[200:203], a[180:183], v[168:171]
    v_mfma_f32_16x16x32_bf16 v[176:179], v[200:203], a[212:215], v[176:179]
    v_mfma_f32_16x16x32_bf16 v[184:187], v[200:203], a[244:247], v[184:187]
    ds_read_b128 v[200:203], v227 offset:16640
    v_mfma_f32_16x16x32_bf16 v[164:167], v[204:207], a[148:151], v[164:167]
    v_mfma_f32_16x16x32_bf16 v[172:175], v[204:207], a[180:183], v[172:175]
    v_mfma_f32_16x16x32_bf16 v[180:183], v[204:207], a[212:215], v[180:183]
    v_mfma_f32_16x16x32_bf16 v[188:191], v[204:207], a[244:247], v[188:191]
    ds_read_b128 v[204:207], v227 offset:24832
    s_waitcnt lgkmcnt(3)
    v_mfma_f32_16x16x32_bf16 v[160:163], v[192:195], a[152:155], v[160:163]
    v_mfma_f32_16x16x32_bf16 v[168:171], v[192:195], a[184:187], v[168:171]
    v_mfma_f32_16x16x32_bf16 v[176:179], v[192:195], a[216:219], v[176:179]
    v_mfma_f32_16x16x32_bf16 v[184:187], v[192:195], a[248:251], v[184:187]
    s_waitcnt lgkmcnt(0)
    s_waitcnt vmcnt(16)
    s_barrier
    s_sub_u32 s24, s24, 1
    s_cmp_lg_u32 s24, 0
    s_cbranch_scc1 L_loop
    ds_read_b64_tr_b16 v[192:193], v228 offset:0
    ds_read_b64_tr_b16 v[194:195], v228 offset:8192
    v_mfma_f32_16x16x32_bf16 v[164:167], v[196:199], a[152:155], v[164:167]
    v_mfma_f32_16x16x32_bf16 v[172:175], v[196:199], a[184:187], v[172:175]
    s_add_u32 m0, s28, 49152
    s_nop 0
    buffer_load_dwordx4 v240, s[12:15], s23 offen offset:0 nt lds
    v_mfma_f32_16x16x32_bf16 v[180:183], v[196:199], a[216:219], v[180:183]
    v_mfma_f32_16x16x32_bf16 v[188:191], v[196:199], a[248:251], v[188:191]
    ds_read_b64_tr_b16 v[196:197], v229 offset:0
    ds_read_b64_tr_b16 v[198:199], v229 offset:8192
    v_mfma_f32_16x16x32_bf16 v[160:163], v[200:203], a[156:159], v[160:163]
    v_mfma_f32_16x16x32_bf16 v[168:171], v[200:203], a[188:191], v[168:171]
    buffer_load_dwordx4 v241, s[12:15], s23 offen offset:1024 nt lds
    v_mfma_f32_16x16x32_bf16 v[176:179], v[200:203], a[220:223], v[176:179]
    v_mfma_f32_16x16x32_bf16 v[184:187], v[200:203], a[252:255], v[184:187]
    ds_read_b64_tr_b16 v[200:201], v230 offset:0
    ds_read_b64_tr_b16 v[202:203], v230 offset:8192
    v_mfma_f32_16x16x32_bf16 v[164:167], v[204:207], a[156:159], v[164:167]
    v_mfma_f32_16x16x32_bf16 v[172:175], v[204:207], a[188:191], v[172:175]
    buffer_load_dwordx4 v242, s[12:15], s23 offen offset:2048 nt lds
    v_mfma_f32_16x16x32_bf16 v[180:183], v[204:207], a[220:223], v[180:183]
    v_mfma_f32_16x16x32_bf16 v[188:191], v[204:207], a[252:255], v[188:191]
    s_cmp_lg_u32 s25, 0
    s_cbranch_scc1 L_stub_9
L_back_9:
    s_waitcnt lgkmcnt(2)
    v_mfma_f32_16x16x32_bf16 v[0:3], v[192:195], v[128:131], v[0:3]
    ds_read_b64_tr_b16 v[204:205], v231 offset:0
    ds_read_b64_tr_b16 v[206:207], v231 offset:8192
    v_mfma_f32_16x16x32_bf16 v[64:67], v[192:195], v[136:139], v[64:67]
    buffer_load_dwordx4 v243, s[12:15], s23 offen offset:3072 nt lds
    s_add_u32 s23, s23, 16384
    v_mfma_f32_16x16x32_bf16 a[0:3], v[192:195], v[144:147], a[0:3]
    v_mfma_f32_16x16x32_bf16 a[64:67], v[192:195], v[152:155], a[64:67]
    ds_read_b64_tr_b16 v[192:193], v232 offset:0
    ds_read_b64_tr_b16 v[194:195], v232 offset:8192
    v_mfma_f32_16x16x32_bf16 v[4:7], v[196:199], v[128:131], v[4:7]
    v_mfma_f32_16x16x32_bf16 v[68:71], v[196:199], v[136:139], v[68:71]
    v_mfma_f32_16x16x32_bf16 a[4:7], v[196:199], v[144:147], a[4:7]
    v_max3_f32 v252, v160, v161, v162
    v_max3_f32 v253, v163, v164, v165
    v_mfma_f32_16x16x32_bf16 a[68:71], v[196:199], v[152:155], a[68:71]
    ds_read_b64_tr_b16 v[196:197], v233 offset:0
    s_waitcnt lgkmcnt(3)
    v_mfma_f32_16x16x32_bf16 v[8:11], v[200:203], v[128:131], v[8:11]
    ds_read_b64_tr_b16 v[198:199], v233 offset:8192
    v_max3_f32 v252, v252, v166, v167
    v_mfma_f32_16x16x32_bf16 v[72:75], v[200:203], v[136:139], v[72:75]
    v_max3_f32 v253, v253, v168, v169
    v_max3_f32 v252, v252, v170, v171
    v_mfma_f32_16x16x32_bf16 a[8:11], v[200:203], v[144:147], a[8:11]
    v_max3_f32 v253, v253, v172, v173
    v_max3_f32 v252, v252, v174, v175
    v_mfma_f32_16x16x32_bf16 a[72:75], v[200:203], v[152:155], a[72:75]
    ds_read_b64_tr_b16 v[200:201], v234 offset:0
    ds_read_b64_tr_b16 v[202:203], v234 offset:8192
    v_mfma_f32_16x16x32_bf16 v[12:15], v[204:207], v[128:131], v[12:15]
    v_max3_f32 v253, v253, v176, v177
    v_max3_f32 v252, v252, v178, v179
    v_mfma_f32_16x16x32_bf16 v[76:79], v[204:207], v[136:139], v[76:79]
    v_max3_f32 v253, v253, v180, v181
    v_max3_f32 v252, v252, v182, v183
    v_mfma_f32_16x16x32_bf16 a[12:15], v[204:207], v[144:147], a[12:15]
    v_max3_f32 v253, v253, v184, v185
    v_max3_f32 v252, v252, v186, v187
    v_mfma_f32_16x16x32_bf16 a[76:79], v[204:207], v[152:155], a[76:79]
    ds_read_b64_tr_b16 v[204:205], v235 offset:0
    s_waitcnt lgkmcnt(3)
    v_mfma_f32_16x16x32_bf16 v[16:19], v[192:195], v[128:131], v[16:19]
    ds_read_b64_tr_b16 v[206:207], v235 offset:8192
    v_max3_f32 v253, v253, v188, v189
    v_mfma_f32_16x16x32_bf16 v[80:83], v[192:195], v[136:139], v[80:83]
    v_max3_f32 v252, v252, v190, v191
    v_max_f32 v252, v252, v253
    v_mfma_f32_16x16x32_bf16 a[16:19], v[192:195], v[144:147], a[16:19]
    v_cmp_lt_f32 vcc, s32, v252
    s_cbranch_vccnz L_stub_10
L_back_10:
    v_mfma_f32_16x16x32_bf16 a[80:83], v[192:195], v[152:155], a[80:83]
    ds_read_b64_tr_b16 v[192:193], v228 offset:256
    ds_read_b64_tr_b16 v[194:195], v228 offset:8448
    v_mfma_f32_16x16x32_bf16 v[20:23], v[196:199], v[128:131], v[20:23]
    v_exp_f32 v160, v160
    v_mfma_f32_16x16x32_bf16 v[84:87], v[196:199], v[136:139], v[84:87]
    v_exp_f32 v161, v161
    v_mfma_f32_16x16x32_bf16 a[20:23], v[196:199], v[144:147], a[20:23]
    v_add_f32 v244, v244, v160
    v_add_f32 v244, v244, v161
    v_mfma_f32_16x16x32_bf16 a[84:87], v[196:199], v[152:155], a[84:87]
    ds_read_b64_tr_b16 v[196:197], v229 offset:256
    s_waitcnt lgkmcnt(3)
    v_mfma_f32_16x16x32_bf16 v[24:27], v[200:203], v[128:131], v[24:27]
    ds_read_b64_tr_b16 v[198:199], v229 offset:8448
    v_cvt_pk_bf16_f32 v160, v160, v161
    v_mfma_f32_16x16x32_bf16 v[88:91], v[200:203], v[136:139], v[88:91]
    v_exp_f32 v162, v162
    v_mfma_f32_16x16x32_bf16 a[24:27], v[200:203], v[144:147], a[24:27]
    v_exp_f32 v163, v163
    v_mfma_f32_16x16x32_bf16 a[88:91], v[200:203], v[152:155], a[88:91]
    ds_read_b64_tr_b16 v[200:201], v230 offset:256
    ds_read_b64_tr_b16 v[202:203], v230 offset:8448
    v_mfma_f32_16x16x32_bf16 v[28:31], v[204:207], v[128:131], v[28:31]
    v_add_f32 v244, v244, v162
    v_add_f32 v244, v244, v163
    v_mfma_f32_16x16x32_bf16 v[92:95], v[204:207], v[136:139], v[92:95]
    v_exp_f32 v164, v164
    v_mfma_f32_16x16x32_bf16 a[28:31], v[204:207], v[144:147], a[28:31]
    v_cvt_pk_bf16_f32 v161, v162, v163
    v_add_f32 v244, v244, v164
    v_mfma_f32_16x16x32_bf16 a[92:95], v[204:207], v[152:155], a[92:95]
    ds_read_b64_tr_b16 v[204:205], v231 offset:256
    s_waitcnt lgkmcnt(3)
    v_mfma_f32_16x16x32_bf16 v[32:35], v[192:195], v[128:131], v[32:35]
    ds_read_b64_tr_b16 v[206:207], v231 offset:8448
    v_mfma_f32_16x16x32_bf16 v[96:99], v[192:195], v[136:139], v[96:99]
    v_exp_f32 v165, v165
    v_mfma_f32_16x16x32_bf16 a[32:35], v[192:195], v[144:147], a[32:35]
    v_exp_f32 v166, v166
    v_mfma_f32_16x16x32_bf16 a[96:99], v[192:195], v[152:155], a[96:99]
    ds_read_b64_tr_b16 v[192:193], v232 offset:256
    ds_read_b64_tr_b16 v[194:195], v232 offset:8448
    v_mfma_f32_16x16x32_bf16 v[36:39], v[196:199], v[128:131], v[36:39]
    v_add_f32 v244, v244, v165
    v_cvt_pk_bf16_f32 v162, v164, v165
    v_mfma_f32_16x16x32_bf16 v[100:103], v[196:199], v[136:139], v[100:103]
    v_exp_f32 v167, v167
    v_mfma_f32_16x16x32_bf16 a[36:39], v[196:199], v[144:147], a[36:39]
    v_add_f32 v244, v244, v166
    v_add_f32 v244, v244, v167
    v_mfma_f32_16x16x32_bf16 a[100:103], v[196:199], v[152:155], a[100:103]
    ds_read_b64_tr_b16 v[196:197], v233 offset:256
    s_waitcnt lgkmcnt(3)
    v_mfma_f32_16x16x32_bf16 v[40:43], v[200:203], v[128:131], v[40:43]
    ds_read_b64_tr_b16 v[198:199], v233 offset:8448
    v_cvt_pk_bf16_f32 v163, v166, v167
    v_mfma_f32_16x16x32_bf16 v[104:107], v[200:203], v[136:139], v[104:107]
    v_exp_f32 v168, v168
    v_mfma_f32_16x16x32_bf16 a[40:43], v[200:203], v[144:147], a[40:43]
    v_exp_f32 v169, v169
    v_mfma_f32_16x16x32_bf16 a[104:107], v[200:203], v[152:155], a[104:107]
    ds_read_b64_tr_b16 v[200:201], v234 offset:256
    ds_read_b64_tr_b16 v[202:203], v234 offset:8448
    v_mfma_f32_16x16x32_bf16 v[44:47], v[204:207], v[128:131], v[44:47]
    v_add_f32 v245, v245, v168
    v_add_f32 v245, v245, v169
    v_mfma_f32_16x16x32_bf16 v[108:111], v[204:207], v[136:139], v[108:111]
    v_exp_f32 v170, v170
    v_mfma_f32_16x16x32_bf16 a[44:47], v[204:207], v[144:147], a[44:47]
    v_cvt_pk_bf16_f32 v168, v168, v169
    v_add_f32 v245, v245, v170
    v_mfma_f32_16x16x32_bf16 a[108:111], v[204:207], v[152:155], a[108:111]
    ds_read_b64_tr_b16 v[204:205], v235 offset:256
    s_waitcnt lgkmcnt(3)
    v_mfma_f32_16x16x32_bf16 v[48:51], v[192:195], v[128:131], v[48:51]
    ds_read_b64_tr_b16 v[206:207], v235 offset:8448
    v_mfma_f32_16x16x32_bf16 v[112:115], v[192:195], v[136:139], v[112:115]
    v_exp_f32 v171, v171
    v_mfma_f32_16x16x32_bf16 a[48:51], v[192:195], v[144:147], a[48:51]
    v_exp_f32 v172, v172
    v_mfma_f32_16x16x32_bf16 a[112:115], v[192:195], v[152:155], a[112:115]
    ds_read_b128 v[192:195], v224 offset:32768
    v_add_f32 v245, v245, v171
    v_mfma_f32_16x16x32_bf16 v[52:55], v[196:199], v[128:131], v[52:55]
    v_cvt_pk_bf16_f32 v169, v170, v171
    v_add_f32 v245, v245, v172
    v_mfma_f32_16x16x32_bf16 v[116:119], v[196:199], v[136:139], v[116:119]
    v_exp_f32 v173, v173
    v_mfma_f32_16x16x32_bf16 a[52:55], v[196:199], v[144:147], a[52:55]
    v_exp_f32 v174, v174
    v_mfma_f32_16x16x32_bf16 a[116:119], v[196:199], v[152:155], a[116:119]
    ds_read_b128 v[196:199], v224 offset:40960
    s_waitcnt lgkmcnt(2)
    v_mfma_f32_16x16x32_bf16 v[56:59], v[200:203], v[128:131], v[56:59]
    v_add_f32 v245, v245, v173
    v_cvt_pk_bf16_f32 v170, v172, v173
    v_mfma_f32_16x16x32_bf16 v[120:123], v[200:203], v[136:139], v[120:123]
    v_exp_f32 v175, v175
    v_mfma_f32_16x16x32_bf16 a[56:59], v[200:203], v[144:147], a[56:59]
    v_add_f32 v245, v245, v174
    v_add_f32 v245, v245, v175
    v_mfma_f32_16x16x32_bf16 a[120:123], v[200:203], v[152:155], a[120:123]
    ds_read_b128 v[200:203], v225 offset:32768
    v_cvt_pk_bf16_f32 v171, v174, v175
    v_mfma_f32_16x16x32_bf16 v[60:63], v[204:207], v[128:131], v[60:63]
    v_exp_f32 v176, v176
    v_mfma_f32_16x16x32_bf16 v[124:127], v[204:207], v[136:139], v[124:127]
    v_exp_f32 v177, v177
    v_mfma_f32_16x16x32_bf16 a[60:63], v[204:207], v[144:147], a[60:63]
    v_add_f32 v246, v246, v176
    v_add_f32 v246, v246, v177
    v_mfma_f32_16x16x32_bf16 a[124:127], v[204:207], v[152:155], a[124:127]
    ds_read_b128 v[204:207], v225 offset:40960
    s_waitcnt lgkmcnt(2)
    v_mfma_f32_16x16x32_bf16 v[128:131], v[192:195], a[128:131], v[208:211]
    v_exp_f32 v178, v178
    v_mfma_f32_16x16x32_bf16 v[136:139], v[192:195], a[160:163], v[212:215]
    v_cvt_pk_bf16_f32 v176, v176, v177
    v_add_f32 v246, v246, v178
    v_mfma_f32_16x16x32_bf16 v[144:147], v[192:195], a[192:195], v[216:219]
    v_exp_f32 v179, v179
    v_mfma_f32_16x16x32_bf16 v[152:155], v[192:195], a[224:227], v[220:223]
    ds_read_b128 v[192:195], v226 offset:32768
    v_add_f32 v246, v246, v179
    v_mfma_f32_16x16x32_bf16 v[132:135], v[196:199], a[128:131], v[208:211]
    v_exp_f32 v180, v180
    v_mfma_f32_16x16x32_bf16 v[140:143], v[196:199], a[160:163], v[212:215]
    v_cvt_pk_bf16_f32 v177, v178, v179
    v_add_f32 v246, v246, v180
    v_mfma_f32_16x16x32_bf16 v[148:151], v[196:199], a[192:195], v[216:219]
    v_exp_f32 v181, v181
    v_mfma_f32_16x16x32_bf16 v[156:159], v[196:199], a[224:227], v[220:223]
    ds_read_b128 v[196:199], v226 offset:40960
    s_waitcnt lgkmcnt(2)
    v_mfma_f32_16x16x32_bf16 v[128:131], v[200:203], a[132:135], v[128:131]
    v_exp_f32 v182, v182
    v_mfma_f32_16x16x32_bf16 v[136:139], v[200:203], a[164:167], v[136:139]
    v_add_f32 v246, v246, v181
    v_cvt_pk_bf16_f32 v178, v180, v181
    v_mfma_f32_16x16x32_bf16 v[144:147], v[200:203], a[196:199], v[144:147]
    v_exp_f32 v183, v183
    v_mfma_f32_16x16x32_bf16 v[152:155], v[200:203], a[228:231], v[152:155]
    ds_read_b128 v[200:203], v227 offset:32768
    v_add_f32 v246, v246, v182
    v_mfma_f32_16x16x32_bf16 v[132:135], v[204:207], a[132:135], v[132:135]
    v_add_f32 v246, v246, v183
    v_cvt_pk_bf16_f32 v179, v182, v183
    v_mfma_f32_16x16x32_bf16 v[140:143], v[204:207], a[164:167], v[140:143]
    v_exp_f32 v184, v184
    v_mfma_f32_16x16x32_bf16 v[148:151], v[204:207], a[196:199], v[148:151]
    v_exp_f32 v185, v185
    v_mfma_f32_16x16x32_bf16 v[156:159], v[204:207], a[228:231], v[156:159]
    ds_read_b128 v[204:207], v227 offset:40960
    s_waitcnt lgkmcnt(2)
    v_mfma_f32_16x16x32_bf16 v[128:131], v[192:195], a[136:139], v[128:131]
    v_add_f32 v247, v247, v184
    v_add_f32 v247, v247, v185
    v_mfma_f32_16x16x32_bf16 v[136:139], v[192:195], a[168:171], v[136:139]
    v_exp_f32 v186, v186
    v_mfma_f32_16x16x32_bf16 v[144:147], v[192:195], a[200:203], v[144:147]
    v_cvt_pk_bf16_f32 v184, v184, v185
    v_add_f32 v247, v247, v186
    v_mfma_f32_16x16x32_bf16 v[152:155], v[192:195], a[232:235], v[152:155]
    ds_read_b128 v[192:195], v224 offset:33024
    v_mfma_f32_16x16x32_bf16 v[132:135], v[196:199], a[136:139], v[132:135]
    v_exp_f32 v187, v187
    v_mfma_f32_16x16x32_bf16 v[140:143], v[196:199], a[168:171], v[140:143]
    v_exp_f32 v188, v188
    v_mfma_f32_16x16x32_bf16 v[148:151], v[196:199], a[200:203], v[148:151]
    v_add_f32 v247, v247, v187
    v_cvt_pk_bf16_f32 v185, v186, v187
    v_mfma_f32_16x16x32_bf16 v[156:159], v[196:199], a[232:235], v[156:159]
    ds_read_b128 v[196:199], v224 offset:41216
    s_waitcnt lgkmcnt(2)
    v_mfma_f32_16x16x32_bf16 v[128:131], v[200:203], a[140:143], v[128:131]
    v_exp_f32 v189, v189
    v_mfma_f32_16x16x32_bf16 v[136:139], v[200:203], a[172:175], v[136:139]
    v_add_f32 v247, v247, v188
    v_add_f32 v247, v247, v189
    v_mfma_f32_16x16x32_bf16 v[144:147], v[200:203], a[204:207], v[144:147]
    v_exp_f32 v190, v190
    v_mfma_f32_16x16x32_bf16 v[152:155], v[200:203], a[236:239], v[152:155]
    ds_read_b128 v[200:203], v225 offset:33024
    v_cvt_pk_bf16_f32 v186, v188, v189
    v_mfma_f32_16x16x32_bf16 v[132:135], v[204:207], a[140:143], v[132:135]
    v_exp_f32 v191, v191
    v_mfma_f32_16x16x32_bf16 v[140:143], v[204:207], a[172:175], v[140:143]
    v_add_f32 v247, v247, v190
    v_add_f32 v247, v247, v191
    v_mfma_f32_16x16x32_bf16 v[148:151], v[204:207], a[204:207], v[148:151]
    v_cvt_pk_bf16_f32 v187, v190, v191
    v_mfma_f32_16x16x32_bf16 v[156:159], v[204:207], a[236:239], v[156:159]
    ds_read_b128 v[204:207], v225 offset:41216
    s_waitcnt lgkmcnt(2)
    v_mfma_f32_16x16x32_bf16 v[128:131], v[192:195], a[144:147], v[128:131]
    v_mfma_f32_16x16x32_bf16 v[136:139], v[192:195], a[176:179], v[136:139]
    v_mfma_f32_16x16x32_bf16 v[144:147], v[192:195], a[208:211], v[144:147]
    v_mfma_f32_16x16x32_bf16 v[152:155], v[192:195], a[240:243], v[152:155]
    ds_read_b128 v[192:195], v226 offset:33024
    v_mfma_f32_16x16x32_bf16 v[132:135], v[196:199], a[144:147], v[132:135]
    v_mfma_f32_16x16x32_bf16 v[140:143], v[196:199], a[176:179], v[140:143]
    v_mfma_f32_16x16x32_bf16 v[148:151], v[196:199], a[208:211], v[148:151]
    v_mfma_f32_16x16x32_bf16 v[156:159], v[196:199], a[240:243], v[156:159]
    ds_read_b128 v[196:199], v226 offset:41216
    s_waitcnt lgkmcnt(2)
    v_mfma_f32_16x16x32_bf16 v[128:131], v[200:203], a[148:151], v[128:131]
    v_mfma_f32_16x16x32_bf16 v[136:139], v[200:203], a[180:183], v[136:139]
    v_mfma_f32_16x16x32_bf16 v[144:147], v[200:203], a[212:215], v[144:147]
    v_mfma_f32_16x16x32_bf16 v[152:155], v[200:203], a[244:247], v[152:155]
    ds_read_b128 v[200:203], v227 offset:33024
    v_mfma_f32_16x16x32_bf16 v[132:135], v[204:207], a[148:151], v[132:135]
    v_mfma_f32_16x16x32_bf16 v[140:143], v[204:207], a[180:183], v[140:143]
    v_mfma_f32_16x16x32_bf16 v[148:151], v[204:207], a[212:215], v[148:151]
    v_mfma_f32_16x16x32_bf16 v[156:159], v[204:207], a[244:247], v[156:159]
    ds_read_b128 v[204:207], v227 offset:41216
    s_waitcnt lgkmcnt(3)
    v_mfma_f32_16x16x32_bf16 v[128:131], v[192:195], a[152:155], v[128:131]
    v_mfma_f32_16x16x32_bf16 v[136:139], v[192:195], a[184:187], v[136:139]
    v_mfma_f32_16x16x32_bf16 v[144:147], v[192:195], a[216:219], v[144:147]
    v_mfma_f32_16x16x32_bf16 v[152:155], v[192:195], a[248:251], v[152:155]
    s_waitcnt lgkmcnt(0)
    s_waitcnt vmcnt(12)
    s_barrier
    ds_read_b64_tr_b16 v[192:193], v228 offset:16384
    ds_read_b64_tr_b16 v[194:195], v228 offset:24576
    v_mfma_f32_16x16x32_bf16 v[132:135], v[196:199], a[152:155], v[132:135]
    v_mfma_f32_16x16x32_bf16 v[140:143], v[196:199], a[184:187], v[140:143]
    v_mfma_f32_16x16x32_bf16 v[148:151], v[196:199], a[216:219], v[148:151]
    v_mfma_f32_16x16x32_bf16 v[156:159], v[196:199], a[248:251], v[156:159]
    ds_read_b64_tr_b16 v[196:197], v229 offset:16384
    ds_read_b64_tr_b16 v[198:199], v229 offset:24576
    v_mfma_f32_16x16x32_bf16 v[128:131], v[200:203], a[156:159], v[128:131]
    v_mfma_f32_16x16x32_bf16 v[136:139], v[200:203], a[188:191], v[136:139]
    v_mfma_f32_16x16x32_bf16 v[144:147], v[200:203], a[220:223], v[144:147]
    v_mfma_f32_16x16x32_bf16 v[152:155], v[200:203], a[252:255], v[152:155]
    ds_read_b64_tr_b16 v[200:201], v230 offset:16384
    ds_read_b64_tr_b16 v[202:203], v230 offset:24576
    v_mfma_f32_16x16x32_bf16 v[132:135], v[204:207], a[156:159], v[132:135]
    v_mfma_f32_16x16x32_bf16 v[140:143], v[204:207], a[188:191], v[140:143]
    v_mfma_f32_16x16x32_bf16 v[148:151], v[204:207], a[220:223], v[148:151]
    v_mfma_f32_16x16x32_bf16 v[156:159], v[204:207], a[252:255], v[156:159]
    s_cmp_lg_u32 s25, 0
    s_cbranch_scc1 L_stub_11
L_back_11:
    s_waitcnt lgkmcnt(2)
    v_mfma_f32_16x16x32_bf16 v[0:3], v[192:195], v[160:163], v[0:3]
    ds_read_b64_tr_b16 v[204:205], v231 offset:16384
    ds_read_b64_tr_b16 v[206:207], v231 offset:24576
    v_mfma_f32_16x16x32_bf16 v[64:67], v[192:195], v[168:171], v[64:67]
    v_mfma_f32_16x16x32_bf16 a[0:3], v[192:195], v[176:179], a[0:3]
    v_mfma_f32_16x16x32_bf16 a[64:67], v[192:195], v[184:187], a[64:67]
    ds_read_b64_tr_b16 v[192:193], v232 offset:16384
    ds_read_b64_tr_b16 v[194:195], v232 offset:24576
    v_mfma_f32_16x16x32_bf16 v[4:7], v[196:199], v[160:163], v[4:7]
    v_mfma_f32_16x16x32_bf16 v[68:71], v[196:199], v[168:171], v[68:71]
    v_mfma_f32_16x16x32_bf16 a[4:7], v[196:199], v[176:179], a[4:7]
    v_max3_f32 v252, v128, v129, v130
    v_max3_f32 v253, v131, v132, v133
    v_mfma_f32_16x16x32_bf16 a[68:71], v[196:199], v[184:187], a[68:71]
    ds_read_b64_tr_b16 v[196:197], v233 offset:16384
    s_waitcnt lgkmcnt(3)
    v_mfma_f32_16x16x32_bf16 v[8:11], v[200:203], v[160:163], v[8:11]
    ds_read_b64_tr_b16 v[198:199], v233 offset:24576
    v_max3_f32 v252, v252, v134, v135
    v_mfma_f32_16x16x32_bf16 v[72:75], v[200:203], v[168:171], v[72:75]
    v_max3_f32 v253, v253, v136, v137
    v_max3_f32 v252, v252, v138, v139
    v_mfma_f32_16x16x32_bf16 a[8:11], v[200:203], v[176:179], a[8:11]
    v_max3_f32 v253, v253, v140, v141
    v_max3_f32 v252, v252, v142, v143
    v_mfma_f32_16x16x32_bf16 a[72:75], v[200:203], v[184:187], a[72:75]
    ds_read_b64_tr_b16 v[200:201], v234 offset:16384
    ds_read_b64_tr_b16 v[202:203], v234 offset:24576
    v_mfma_f32_16x16x32_bf16 v[12:15], v[204:207], v[160:163], v[12:15]
    v_max3_f32 v253, v253, v144, v145
    v_max3_f32 v252, v252, v146, v147
    v_mfma_f32_16x16x32_bf16 v[76:79], v[204:207], v[168:171], v[76:79]
    v_max3_f32 v253, v253, v148, v149
    v_max3_f32 v252, v252, v150, v151
    v_mfma_f32_16x16x32_bf16 a[12:15], v[204:207], v[176:179], a[12:15]
    v_max3_f32 v253, v253, v152, v153
    v_max3_f32 v252, v252, v154, v155
    v_mfma_f32_16x16x32_bf16 a[76:79], v[204:207], v[184:187], a[76:79]
    ds_read_b64_tr_b16 v[204:205], v235 offset:16384
    s_waitcnt lgkmcnt(3)
    v_mfma_f32_16x16x32_bf16 v[16:19], v[192:195], v[160:163], v[16:19]
    ds_read_b64_tr_b16 v[206:207], v235 offset:24576
    v_max3_f32 v253, v253, v156, v157
    v_mfma_f32_16x16x32_bf16 v[80:83], v[192:195], v[168:171], v[80:83]
    v_max3_f32 v252, v252, v158, v159
    v_max_f32 v252, v252, v253
    v_mfma_f32_16x16x32_bf16 a[16:19], v[192:195], v[176:179], a[16:19]
    v_cmp_lt_f32 vcc, s32, v252
    s_cbranch_vccnz L_stub_12
L_back_12:
    v_mfma_f32_16x16x32_bf16 a[80:83], v[192:195], v[184:187], a[80:83]
    ds_read_b64_tr_b16 v[192:193], v228 offset:16640
    ds_read_b64_tr_b16 v[194:195], v228 offset:24832
    v_mfma_f32_16x16x32_bf16 v[20:23], v[196:199], v[160:163], v[20:23]
    v_exp_f32 v128, v128
    v_mfma_f32_16x16x32_bf16 v[84:87], v[196:199], v[168:171], v[84:87]
    v_exp_f32 v129, v129
    v_mfma_f32_16x16x32_bf16 a[20:23], v[196:199], v[176:179], a[20:23]
    v_add_f32 v244, v244, v128
    v_add_f32 v244, v244, v129
    v_mfma_f32_16x16x32_bf16 a[84:87], v[196:199], v[184:187], a[84:87]
    ds_read_b64_tr_b16 v[196:197], v229 offset:16640
    s_waitcnt lgkmcnt(3)
    v_mfma_f32_16x16x32_bf16 v[24:27], v[200:203], v[160:163], v[24:27]
    ds_read_b64_tr_b16 v[198:199], v229 offset:24832
    v_cvt_pk_bf16_f32 v128, v128, v129
    v_mfma_f32_16x16x32_bf16 v[88:91], v[200:203], v[168:171], v[88:91]
    v_exp_f32 v130, v130
    v_mfma_f32_16x16x32_bf16 a[24:27], v[200:203], v[176:179], a[24:27]
    v_exp_f32 v131, v131
    v_mfma_f32_16x16x32_bf16 a[88:91], v[200:203], v[184:187], a[88:91]
    ds_read_b64_tr_b16 v[200:201], v230 offset:16640
    ds_read_b64_tr_b16 v[202:203], v230 offset:24832
    v_mfma_f32_16x16x32_bf16 v[28:31], v[204:207], v[160:163], v[28:31]
    v_add_f32 v244, v244, v130
    v_add_f32 v244, v244, v131
    v_mfma_f32_16x16x32_bf16 v[92:95], v[204:207], v[168:171], v[92:95]
    v_exp_f32 v132, v132
    v_mfma_f32_16x16x32_bf16 a[28:31], v[204:207], v[176:179], a[28:31]
    v_cvt_pk_bf16_f32 v129, v130, v131
    v_add_f32 v244, v244, v132
    v_mfma_f32_16x16x32_bf16 a[92:95], v[204:207], v[184:187], a[92:95]
    ds_read_b64_tr_b16 v[204:205], v231 offset:16640
    s_waitcnt lgkmcnt(3)
    v_mfma_f32_16x16x32_bf16 v[32:35], v[192:195], v[160:163], v[32:35]
    ds_read_b64_tr_b16 v[206:207], v231 offset:24832
    v_mfma_f32_16x16x32_bf16 v[96:99], v[192:195], v[168:171], v[96:99]
    v_exp_f32 v133, v133
    v_mfma_f32_16x16x32_bf16 a[32:35], v[192:195], v[176:179], a[32:35]
    v_exp_f32 v134, v134
    v_mfma_f32_16x16x32_bf16 a[96:99], v[192:195], v[184:187], a[96:99]
    ds_read_b64_tr_b16 v[192:193], v232 offset:16640
    ds_read_b64_tr_b16 v[194:195], v232 offset:24832
    v_mfma_f32_16x16x32_bf16 v[36:39], v[196:199], v[160:163], v[36:39]
    v_add_f32 v244, v244, v133
    v_cvt_pk_bf16_f32 v130, v132, v133
    v_mfma_f32_16x16x32_bf16 v[100:103], v[196:199], v[168:171], v[100:103]
    v_exp_f32 v135, v135
    v_mfma_f32_16x16x32_bf16 a[36:39], v[196:199], v[176:179], a[36:39]
    v_add_f32 v244, v244, v134
    v_add_f32 v244, v244, v135
    v_mfma_f32_16x16x32_bf16 a[100:103], v[196:199], v[184:187], a[100:103]
    ds_read_b64_tr_b16 v[196:197], v233 offset:16640
    s_waitcnt lgkmcnt(3)
    v_mfma_f32_16x16x32_bf16 v[40:43], v[200:203], v[160:163], v[40:43]
    ds_read_b64_tr_b16 v[198:199], v233 offset:24832
    v_cvt_pk_bf16_f32 v131, v134, v135
    v_mfma_f32_16x16x32_bf16 v[104:107], v[200:203], v[168:171], v[104:107]
    v_exp_f32 v136, v136
    v_mfma_f32_16x16x32_bf16 a[40:43], v[200:203], v[176:179], a[40:43]
    v_exp_f32 v137, v137
    v_mfma_f32_16x16x32_bf16 a[104:107], v[200:203], v[184:187], a[104:107]
    ds_read_b64_tr_b16 v[200:201], v234 offset:16640
    ds_read_b64_tr_b16 v[202:203], v234 offset:24832
    v_mfma_f32_16x16x32_bf16 v[44:47], v[204:207], v[160:163], v[44:47]
    v_add_f32 v245, v245, v136
    v_add_f32 v245, v245, v137
    v_mfma_f32_16x16x32_bf16 v[108:111], v[204:207], v[168:171], v[108:111]
    v_exp_f32 v138, v138
    v_mfma_f32_16x16x32_bf16 a[44:47], v[204:207], v[176:179], a[44:47]
    v_cvt_pk_bf16_f32 v136, v136, v137
    v_add_f32 v245, v245, v138
    v_mfma_f32_16x16x32_bf16 a[108:111], v[204:207], v[184:187], a[108:111]
    ds_read_b64_tr_b16 v[204:205], v235 offset:16640
    s_waitcnt lgkmcnt(3)
    v_mfma_f32_16x16x32_bf16 v[48:51], v[192:195], v[160:163], v[48:51]
    ds_read_b64_tr_b16 v[206:207], v235 offset:24832
    v_mfma_f32_16x16x32_bf16 v[112:115], v[192:195], v[168:171], v[112:115]
    v_exp_f32 v139, v139
    v_mfma_f32_16x16x32_bf16 a[48:51], v[192:195], v[176:179], a[48:51]
    v_exp_f32 v140, v140
    v_mfma_f32_16x16x32_bf16 a[112:115], v[192:195], v[184:187], a[112:115]
    ds_read_b128 v[192:195], v224 offset:49152
    v_add_f32 v245, v245, v139
    v_mfma_f32_16x16x32_bf16 v[52:55], v[196:199], v[160:163], v[52:55]
    v_cvt_pk_bf16_f32 v137, v138, v139
    v_add_f32 v245, v245, v140
    v_mfma_f32_16x16x32_bf16 v[116:119], v[196:199], v[168:171], v[116:119]
    v_exp_f32 v141, v141
    v_mfma_f32_16x16x32_bf16 a[52:55], v[196:199], v[176:179], a[52:55]
    v_exp_f32 v142, v142
    v_mfma_f32_16x16x32_bf16 a[116:119], v[196:199], v[184:187], a[116:119]
    ds_read_b128 v[196:199], v224 offset:57344
    s_waitcnt lgkmcnt(2)
    v_mfma_f32_16x16x32_bf16 v[56:59], v[200:203], v[160:163], v[56:59]
    v_add_f32 v245, v245, v141
    v_cvt_pk_bf16_f32 v138, v140, v141
    v_mfma_f32_16x16x32_bf16 v[120:123], v[200:203], v[168:171], v[120:123]
    v_exp_f32 v143, v143
    v_mfma_f32_16x16x32_bf16 a[56:59], v[200:203], v[176:179], a[56:59]
    v_add_f32 v245, v245, v142
    v_add_f32 v245, v245, v143
    v_mfma_f32_16x16x32_bf16 a[120:123], v[200:203], v[184:187], a[120:123]
    ds_read_b128 v[200:203], v225 offset:49152
    v_cvt_pk_bf16_f32 v139, v142, v143
    v_mfma_f32_16x16x32_bf16 v[60:63], v[204:207], v[160:163], v[60:63]
    v_exp_f32 v144, v144
    v_mfma_f32_16x16x32_bf16 v[124:127], v[204:207], v[168:171], v[124:127]
    v_exp_f32 v145, v145
    v_mfma_f32_16x16x32_bf16 a[60:63], v[204:207], v[176:179], a[60:63]
    v_add_f32 v246, v246, v144
    v_add_f32 v246, v246, v145
    v_mfma_f32_16x16x32_bf16 a[124:127], v[204:207], v[184:187], a[124:127]
    ds_read_b128 v[204:207], v225 offset:57344
    s_waitcnt lgkmcnt(2)
    v_mfma_f32_16x16x32_bf16 v[160:163], v[192:195], a[128:131], v[208:211]
    v_exp_f32 v146, v146
    v_mfma_f32_16x16x32_bf16 v[168:171], v[192:195], a[160:163], v[212:215]
    v_cvt_pk_bf16_f32 v144, v144, v145
    v_add_f32 v246, v246, v146
    v_mfma_f32_16x16x32_bf16 v[176:179], v[192:195], a[192:195], v[216:219]
    v_exp_f32 v147, v147
    v_mfma_f32_16x16x32_bf16 v[184:187], v[192:195], a[224:227], v[220:223]
    ds_read_b128 v[192:195], v226 offset:49152
    v_add_f32 v246, v246, v147
    v_mfma_f32_16x16x32_bf16 v[164:167], v[196:199], a[128:131], v[208:211]
    v_exp_f32 v148, v148
    v_mfma_f32_16x16x32_bf16 v[172:175], v[196:199], a[160:163], v[212:215]
    v_cvt_pk_bf16_f32 v145, v146, v147
    v_add_f32 v246, v246, v148
    v_mfma_f32_16x16x32_bf16 v[180:183], v[196:199], a[192:195], v[216:219]
    v_exp_f32 v149, v149
    v_mfma_f32_16x16x32_bf16 v[188:191], v[196:199], a[224:227], v[220:223]
    ds_read_b128 v[196:199], v226 offset:57344
    s_waitcnt lgkmcnt(2)
    v_mfma_f32_16x16x32_bf16 v[160:163], v[200:203], a[132:135], v[160:163]
    v_exp_f32 v150, v150
    v_mfma_f32_16x16x32_bf16 v[168:171], v[200:203], a[164:167], v[168:171]
    v_add_f32 v246, v246, v149
    v_cvt_pk_bf16_f32 v146, v148, v149
    v_mfma_f32_16x16x32_bf16 v[176:179], v[200:203], a[196:199], v[176:179]
    v_exp_f32 v151, v151
    v_mfma_f32_16x16x32_bf16 v[184:187], v[200:203], a[228:231], v[184:187]
    ds_read_b128 v[200:203], v227 offset:49152
    v_add_f32 v246, v246, v150
    v_mfma_f32_16x16x32_bf16 v[164:167], v[204:207], a[132:135], v[164:167]
    v_add_f32 v246, v246, v151
    v_cvt_pk_bf16_f32 v147, v150, v151
    v_mfma_f32_16x16x32_bf16 v[172:175], v[204:207], a[164:167], v[172:175]
    v_exp_f32 v152, v152
    v_mfma_f32_16x16x32_bf16 v[180:183], v[204:207], a[196:199], v[180:183]
    v_exp_f32 v153, v153
    v_mfma_f32_16x16x32_bf16 v[188:191], v[204:207], a[228:231], v[188:191]
    ds_read_b128 v[204:207], v227 offset:57344
    s_waitcnt lgkmcnt(2)
    v_mfma_f32_16x16x32_bf16 v[160:163], v[192:195], a[136:139], v[160:163]
    v_add_f32 v247, v247, v152
    v_add_f32 v247, v247, v153
    v_mfma_f32_16x16x32_bf16 v[168:171], v[192:195], a[168:171], v[168:171]
    v_exp_f32 v154, v154
    v_mfma_f32_16x16x32_bf16 v[176:179], v[192:195], a[200:203], v[176:179]
    v_cvt_pk_bf16_f32 v152, v152, v153
    v_add_f32 v247, v247, v154
    v_mfma_f32_16x16x32_bf16 v[184:187], v[192:195], a[232:235], v[184:187]
    ds_read_b128 v[192:195], v224 offset:49408
    v_mfma_f32_16x16x32_bf16 v[164:167], v[196:199], a[136:139], v[164:167]
    v_exp_f32 v155, v155
    v_mfma_f32_16x16x32_bf16 v[172:175], v[196:199], a[168:171], v[172:175]
    v_exp_f32 v156, v156
    v_mfma_f32_16x16x32_bf16 v[180:183], v[196:199], a[200:203], v[180:183]
    v_add_f32 v247, v247, v155
    v_cvt_pk_bf16_f32 v153, v154, v155
    v_mfma_f32_16x16x32_bf16 v[188:191], v[196:199], a[232:235], v[188:191]
    ds_read_b128 v[196:199], v224 offset:57600
    s_waitcnt lgkmcnt(2)
    v_mfma_f32_16x16x32_bf16 v[160:163], v[200:203], a[140:143], v[160:163]
    v_exp_f32 v157, v157
    v_mfma_f32_16x16x32_bf16 v[168:171], v[200:203], a[172:175], v[168:171]
    v_add_f32 v247, v247, v156
    v_add_f32 v247, v247, v157
    v_mfma_f32_16x16x32_bf16 v[176:179], v[200:203], a[204:207], v[176:179]
    v_exp_f32 v158, v158
    v_mfma_f32_16x16x32_bf16 v[184:187], v[200:203], a[236:239], v[184:187]
    ds_read_b128 v[200:203], v225 offset:49408
    v_cvt_pk_bf16_f32 v154, v156, v157
    v_mfma_f32_16x16x32_bf16 v[164:167], v[204:207], a[140:143], v[164:167]
    v_exp_f32 v159, v159
    v_mfma_f32_16x16x32_bf16 v[172:175], v[204:207], a[172:175], v[172:175]
    v_add_f32 v247, v247, v158
    v_add_f32 v247, v247, v159
    v_mfma_f32_16x16x32_bf16 v[180:183], v[204:207], a[204:207], v[180:183]
    v_cvt_pk_bf16_f32 v155, v158, v159
    v_mfma_f32_16x16x32_bf16 v[188:191], v[204:207], a[236:239], v[188:191]
    ds_read_b128 v[204:207], v225 offset:57600
    s_waitcnt lgkmcnt(2)
    v_mfma_f32_16x16x32_bf16 v[160:163], v[192:195], a[144:147], v[160:163]
    v_mfma_f32_16x16x32_bf16 v[168:171], v[192:195], a[176:179], v[168:171]
    v_mfma_f32_16x16x32_bf16 v[176:179], v[192:195], a[208:211], v[176:179]
    v_mfma_f32_16x16x32_bf16 v[184:187], v[192:195], a[240:243], v[184:187]
    ds_read_b128 v[192:195], v226 offset:49408
    v_mfma_f32_16x16x32_bf16 v[164:167], v[196:199], a[144:147], v[164:167]
    v_mfma_f32_16x16x32_bf16 v[172:175], v[196:199], a[176:179], v[172:175]
    v_mfma_f32_16x16x32_bf16 v[180:183], v[196:199], a[208:211], v[180:183]
    v_mfma_f32_16x16x32_bf16 v[188:191], v[196:199], a[240:243], v[188:191]
    ds_read_b128 v[196:199], v226 offset:57600
    s_waitcnt lgkmcnt(2)
    v_mfma_f32_16x16x32_bf16 v[160:163], v[200:203], a[148:151], v[160:163]
    v_mfma_f32_16x16x32_bf16 v[168:171], v[200:203], a[180:183], v[168:171]
    v_mfma_f32_16x16x32_bf16 v[176:179], v[200:203], a[212:215], v[176:179]
    v_mfma_f32_16x16x32_bf16 v[184:187], v[200:203], a[244:247], v[184:187]
    ds_read_b128 v[200:203], v227 offset:49408
    v_mfma_f32_16x16x32_bf16 v[164:167], v[204:207], a[148:151], v[164:167]
    v_mfma_f32_16x16x32_bf16 v[172:175], v[204:207], a[180:183], v[172:175]
    v_mfma_f32_16x16x32_bf16 v[180:183], v[204:207], a[212:215], v[180:183]
    v_mfma_f32_16x16x32_bf16 v[188:191], v[204:207], a[244:247], v[188:191]
    ds_read_b128 v[204:207], v227 offset:57600
    s_waitcnt lgkmcnt(3)
    v_mfma_f32_16x16x32_bf16 v[160:163], v[192:195], a[152:155], v[160:163]
    v_mfma_f32_16x16x32_bf16 v[168:171], v[192:195], a[184:187], v[168:171]
    v_mfma_f32_16x16x32_bf16 v[176:179], v[192:195], a[216:219], v[176:179]
    v_mfma_f32_16x16x32_bf16 v[184:187], v[192:195], a[248:251], v[184:187]
    s_waitcnt lgkmcnt(0)
    s_waitcnt vmcnt(0)
    s_barrier
    ds_read_b64_tr_b16 v[192:193], v228 offset:32768
    ds_read_b64_tr_b16 v[194:195], v228 offset:40960
    v_mfma_f32_16x16x32_bf16 v[164:167], v[196:199], a[152:155], v[164:167]
    v_mfma_f32_16x16x32_bf16 v[172:175], v[196:199], a[184:187], v[172:175]
    v_mfma_f32_16x16x32_bf16 v[180:183], v[196:199], a[216:219], v[180:183]
    v_mfma_f32_16x16x32_bf16 v[188:191], v[196:199], a[248:251], v[188:191]
    ds_read_b64_tr_b16 v[196:197], v229 offset:32768
    ds_read_b64_tr_b16 v[198:199], v229 offset:40960
    v_mfma_f32_16x16x32_bf16 v[160:163], v[200:203], a[156:159], v[160:163]
    v_mfma_f32_16x16x32_bf16 v[168:171], v[200:203], a[188:191], v[168:171]
    v_mfma_f32_16x16x32_bf16 v[176:179], v[200:203], a[220:223], v[176:179]
    v_mfma_f32_16x16x32_bf16 v[184:187], v[200:203], a[252:255], v[184:187]
    ds_read_b64_tr_b16 v[200:201], v230 offset:32768
    ds_read_b64_tr_b16 v[202:203], v230 offset:40960
    v_mfma_f32_16x16x32_bf16 v[164:167], v[204:207], a[156:159], v[164:167]
    v_mfma_f32_16x16x32_bf16 v[172:175], v[204:207], a[188:191], v[172:175]
    v_mfma_f32_16x16x32_bf16 v[180:183], v[204:207], a[220:223], v[180:183]
    v_mfma_f32_16x16x32_bf16 v[188:191], v[204:207], a[252:255], v[188:191]
    s_cmp_lg_u32 s25, 0
    s_cbranch_scc1 L_stub_13
L_back_13:
    s_waitcnt lgkmcnt(2)
    v_mfma_f32_16x16x32_bf16 v[0:3], v[192:195], v[128:131], v[0:3]
    ds_read_b64_tr_b16 v[204:205], v231 offset:32768
    ds_read_b64_tr_b16 v[206:207], v231 offset:40960
    v_mfma_f32_16x16x32_bf16 v[64:67], v[192:195], v[136:139], v[64:67]
    v_mfma_f32_16x16x32_bf16 a[0:3], v[192:195], v[144:147], a[0:3]
    v_mfma_f32_16x16x32_bf16 a[64:67], v[192:195], v[152:155], a[64:67]
    ds_read_b64_tr_b16 v[192:193], v232 offset:32768
    ds_read_b64_tr_b16 v[194:195], v232 offset:40960
    v_mfma_f32_16x16x32_bf16 v[4:7], v[196:199], v[128:131], v[4:7]
    v_mfma_f32_16x16x32_bf16 v[68:71], v[196:199], v[136:139], v[68:71]
    v_mfma_f32_16x16x32_bf16 a[4:7], v[196:199], v[144:147], a[4:7]
    v_max3_f32 v252, v160, v161, v162
    v_max3_f32 v253, v163, v164, v165
    v_mfma_f32_16x16x32_bf16 a[68:71], v[196:199], v[152:155], a[68:71]
    ds_read_b64_tr_b16 v[196:197], v233 offset:32768
    s_waitcnt lgkmcnt(3)
    v_mfma_f32_16x16x32_bf16 v[8:11], v[200:203], v[128:131], v[8:11]
    ds_read_b64_tr_b16 v[198:199], v233 offset:40960
    v_max3_f32 v252, v252, v166, v167
    v_mfma_f32_16x16x32_bf16 v[72:75], v[200:203], v[136:139], v[72:75]
    v_max3_f32 v253, v253, v168, v169
    v_max3_f32 v252, v252, v170, v171
    v_mfma_f32_16x16x32_bf16 a[8:11], v[200:203], v[144:147], a[8:11]
    v_max3_f32 v253, v253, v172, v173
    v_max3_f32 v252, v252, v174, v175
    v_mfma_f32_16x16x32_bf16 a[72:75], v[200:203], v[152:155], a[72:75]
    ds_read_b64_tr_b16 v[200:201], v234 offset:32768
    ds_read_b64_tr_b16 v[202:203], v234 offset:40960
    v_mfma_f32_16x16x32_bf16 v[12:15], v[204:207], v[128:131], v[12:15]
    v_max3_f32 v253, v253, v176, v177
    v_max3_f32 v252, v252, v178, v179
    v_mfma_f32_16x16x32_bf16 v[76:79], v[204:207], v[136:139], v[76:79]
    v_max3_f32 v253, v253, v180, v181
    v_max3_f32 v252, v252, v182, v183
    v_mfma_f32_16x16x32_bf16 a[12:15], v[204:207], v[144:147], a[12:15]
    v_max3_f32 v253, v253, v184, v185
    v_max3_f32 v252, v252, v186, v187
    v_mfma_f32_16x16x32_bf16 a[76:79], v[204:207], v[152:155], a[76:79]
    ds_read_b64_tr_b16 v[204:205], v235 offset:32768
    s_waitcnt lgkmcnt(3)
    v_mfma_f32_16x16x32_bf16 v[16:19], v[192:195], v[128:131], v[16:19]
    ds_read_b64_tr_b16 v[206:207], v235 offset:40960
    v_max3_f32 v253, v253, v188, v189
    v_mfma_f32_16x16x32_bf16 v[80:83], v[192:195], v[136:139], v[80:83]
    v_max3_f32 v252, v252, v190, v191
    v_max_f32 v252, v252, v253
    v_mfma_f32_16x16x32_bf16 a[16:19], v[192:195], v[144:147], a[16:19]
    v_cmp_lt_f32 vcc, s32, v252
    s_cbranch_vccnz L_stub_14
L_back_14:
    v_mfma_f32_16x16x32_bf16 a[80:83], v[192:195], v[152:155], a[80:83]
    ds_read_b64_tr_b16 v[192:193], v228 offset:33024
    ds_read_b64_tr_b16 v[194:195], v228 offset:41216
    v_mfma_f32_16x16x32_bf16 v[20:23], v[196:199], v[128:131], v[20:23]
    v_exp_f32 v160, v160
    v_mfma_f32_16x16x32_bf16 v[84:87], v[196:199], v[136:139], v[84:87]
    v_exp_f32 v161, v161
    v_mfma_f32_16x16x32_bf16 a[20:23], v[196:199], v[144:147], a[20:23]
    v_add_f32 v244, v244, v160
    v_add_f32 v244, v244, v161
    v_mfma_f32_16x16x32_bf16 a[84:87], v[196:199], v[152:155], a[84:87]
    ds_read_b64_tr_b16 v[196:197], v229 offset:33024
    s_waitcnt lgkmcnt(3)
    v_mfma_f32_16x16x32_bf16 v[24:27], v[200:203], v[128:131], v[24:27]
    ds_read_b64_tr_b16 v[198:199], v229 offset:41216
    v_cvt_pk_bf16_f32 v160, v160, v161
    v_mfma_f32_16x16x32_bf16 v[88:91], v[200:203], v[136:139], v[88:91]
    v_exp_f32 v162, v162
    v_mfma_f32_16x16x32_bf16 a[24:27], v[200:203], v[144:147], a[24:27]
    v_exp_f32 v163, v163
    v_mfma_f32_16x16x32_bf16 a[88:91], v[200:203], v[152:155], a[88:91]
    ds_read_b64_tr_b16 v[200:201], v230 offset:33024
    ds_read_b64_tr_b16 v[202:203], v230 offset:41216
    v_mfma_f32_16x16x32_bf16 v[28:31], v[204:207], v[128:131], v[28:31]
    v_add_f32 v244, v244, v162
    v_add_f32 v244, v244, v163
    v_mfma_f32_16x16x32_bf16 v[92:95], v[204:207], v[136:139], v[92:95]
    v_exp_f32 v164, v164
    v_mfma_f32_16x16x32_bf16 a[28:31], v[204:207], v[144:147], a[28:31]
    v_cvt_pk_bf16_f32 v161, v162, v163
    v_add_f32 v244, v244, v164
    v_mfma_f32_16x16x32_bf16 a[92:95], v[204:207], v[152:155], a[92:95]
    ds_read_b64_tr_b16 v[204:205], v231 offset:33024
    s_waitcnt lgkmcnt(3)
    v_mfma_f32_16x16x32_bf16 v[32:35], v[192:195], v[128:131], v[32:35]
    ds_read_b64_tr_b16 v[206:207], v231 offset:41216
    v_mfma_f32_16x16x32_bf16 v[96:99], v[192:195], v[136:139], v[96:99]
    v_exp_f32 v165, v165
    v_mfma_f32_16x16x32_bf16 a[32:35], v[192:195], v[144:147], a[32:35]
    v_exp_f32 v166, v166
    v_mfma_f32_16x16x32_bf16 a[96:99], v[192:195], v[152:155], a[96:99]
    ds_read_b64_tr_b16 v[192:193], v232 offset:33024
    ds_read_b64_tr_b16 v[194:195], v232 offset:41216
    v_mfma_f32_16x16x32_bf16 v[36:39], v[196:199], v[128:131], v[36:39]
    v_add_f32 v244, v244, v165
    v_cvt_pk_bf16_f32 v162, v164, v165
    v_mfma_f32_16x16x32_bf16 v[100:103], v[196:199], v[136:139], v[100:103]
    v_exp_f32 v167, v167
    v_mfma_f32_16x16x32_bf16 a[36:39], v[196:199], v[144:147], a[36:39]
    v_add_f32 v244, v244, v166
    v_add_f32 v244, v244, v167
    v_mfma_f32_16x16x32_bf16 a[100:103], v[196:199], v[152:155], a[100:103]
    ds_read_b64_tr_b16 v[196:197], v233 offset:33024
    s_waitcnt lgkmcnt(3)
    v_mfma_f32_16x16x32_bf16 v[40:43], v[200:203], v[128:131], v[40:43]
    ds_read_b64_tr_b16 v[198:199], v233 offset:41216
    v_cvt_pk_bf16_f32 v163, v166, v167
    v_mfma_f32_16x16x32_bf16 v[104:107], v[200:203], v[136:139], v[104:107]
    v_exp_f32 v168, v168
    v_mfma_f32_16x16x32_bf16 a[40:43], v[200:203], v[144:147], a[40:43]
    v_exp_f32 v169, v169
    v_mfma_f32_16x16x32_bf16 a[104:107], v[200:203], v[152:155], a[104:107]
    ds_read_b64_tr_b16 v[200:201], v234 offset:33024
    ds_read_b64_tr_b16 v[202:203], v234 offset:41216
    v_mfma_f32_16x16x32_bf16 v[44:47], v[204:207], v[128:131], v[44:47]
    v_add_f32 v245, v245, v168
    v_add_f32 v245, v245, v169
    v_mfma_f32_16x16x32_bf16 v[108:111], v[204:207], v[136:139], v[108:111]
    v_exp_f32 v170, v170
    v_mfma_f32_16x16x32_bf16 a[44:47], v[204:207], v[144:147], a[44:47]
    v_cvt_pk_bf16_f32 v168, v168, v169
    v_add_f32 v245, v245, v170
    v_mfma_f32_16x16x32_bf16 a[108:111], v[204:207], v[152:155], a[108:111]
    ds_read_b64_tr_b16 v[204:205], v235 offset:33024
    s_waitcnt lgkmcnt(3)
    v_mfma_f32_16x16x32_bf16 v[48:51], v[192:195], v[128:131], v[48:51]
    ds_read_b64_tr_b16 v[206:207], v235 offset:41216
    v_mfma_f32_16x16x32_bf16 v[112:115], v[192:195], v[136:139], v[112:115]
    v_exp_f32 v171, v171
    v_mfma_f32_16x16x32_bf16 a[48:51], v[192:195], v[144:147], a[48:51]
    v_exp_f32 v172, v172
    v_mfma_f32_16x16x32_bf16 a[112:115], v[192:195], v[152:155], a[112:115]
    v_add_f32 v245, v245, v171
    v_cvt_pk_bf16_f32 v169, v170, v171
    v_mfma_f32_16x16x32_bf16 v[52:55], v[196:199], v[128:131], v[52:55]
    v_exp_f32 v173, v173
    v_mfma_f32_16x16x32_bf16 v[116:119], v[196:199], v[136:139], v[116:119]
    v_add_f32 v245, v245, v172
    v_add_f32 v245, v245, v173
    v_mfma_f32_16x16x32_bf16 a[52:55], v[196:199], v[144:147], a[52:55]
    v_exp_f32 v174, v174
    v_mfma_f32_16x16x32_bf16 a[116:119], v[196:199], v[152:155], a[116:119]
    v_cvt_pk_bf16_f32 v170, v172, v173
    s_waitcnt lgkmcnt(0)
    v_mfma_f32_16x16x32_bf16 v[56:59], v[200:203], v[128:131], v[56:59]
    v_exp_f32 v175, v175
    v_mfma_f32_16x16x32_bf16 v[120:123], v[200:203], v[136:139], v[120:123]
    v_add_f32 v245, v245, v174
    v_add_f32 v245, v245, v175
    v_mfma_f32_16x16x32_bf16 a[56:59], v[200:203], v[144:147], a[56:59]
    v_cvt_pk_bf16_f32 v171, v174, v175
    v_mfma_f32_16x16x32_bf16 a[120:123], v[200:203], v[152:155], a[120:123]
    v_exp_f32 v176, v176
    v_mfma_f32_16x16x32_bf16 v[60:63], v[204:207], v[128:131], v[60:63]
    v_exp_f32 v177, v177
    v_mfma_f32_16x16x32_bf16 v[124:127], v[204:207], v[136:139], v[124:127]
    v_add_f32 v246, v246, v176
    v_add_f32 v246, v246, v177
    v_exp_f32 v178, v178
    v_cvt_pk_bf16_f32 v176, v176, v177
    v_exp_f32 v179, v179
    v_add_f32 v246, v246, v178
    v_exp_f32 v180, v180
    v_add_f32 v246, v246, v179
    v_cvt_pk_bf16_f32 v177, v178, v179
    v_exp_f32 v181, v181
    v_add_f32 v246, v246, v180
    v_exp_f32 v182, v182
    v_add_f32 v246, v246, v181
    v_cvt_pk_bf16_f32 v178, v180, v181
    v_exp_f32 v183, v183
    v_add_f32 v246, v246, v182
    v_add_f32 v246, v246, v183
    v_cvt_pk_bf16_f32 v179, v182, v183
    v_exp_f32 v184, v184
    v_exp_f32 v185, v185
    v_add_f32 v247, v247, v184
    v_exp_f32 v186, v186
    v_add_f32 v247, v247, v185
    v_cvt_pk_bf16_f32 v184, v184, v185
    v_exp_f32 v187, v187
    v_add_f32 v247, v247, v186
    v_exp_f32 v188, v188
    v_add_f32 v247, v247, v187
    v_cvt_pk_bf16_f32 v185, v186, v187
    v_exp_f32 v189, v189
    v_add_f32 v247, v247, v188
    v_exp_f32 v190, v190
    v_add_f32 v247, v247, v189
    v_cvt_pk_bf16_f32 v186, v188, v189
    v_exp_f32 v191, v191
    v_add_f32 v247, v247, v190
    v_add_f32 v247, v247, v191
    v_cvt_pk_bf16_f32 v187, v190, v191
    v_mfma_f32_16x16x32_bf16 a[60:63], v[204:207], v[144:147], a[60:63]
    v_mfma_f32_16x16x32_bf16 a[124:127], v[204:207], v[152:155], a[124:127]
    ds_read_b64_tr_b16 v[192:193], v228 offset:49152
    ds_read_b64_tr_b16 v[194:195], v228 offset:57344
    ds_read_b64_tr_b16 v[196:197], v229 offset:49152
    ds_read_b64_tr_b16 v[198:199], v229 offset:57344
    ds_read_b64_tr_b16 v[200:201], v230 offset:49152
    ds_read_b64_tr_b16 v[202:203], v230 offset:57344
    ds_read_b64_tr_b16 v[204:205], v231 offset:49152
    ds_read_b64_tr_b16 v[206:207], v231 offset:57344
    s_cmp_lg_u32 s25, 0
    s_cbranch_scc1 L_stub_15
L_back_15:
    s_waitcnt lgkmcnt(4)
    v_mfma_f32_16x16x32_bf16 v[0:3], v[192:195], v[160:163], v[0:3]
    v_mbcnt_lo_u32_b32 v227, -1, 0
    v_mbcnt_hi_u32_b32 v227, -1, v227
    v_mfma_f32_16x16x32_bf16 v[64:67], v[192:195], v[168:171], v[64:67]
    s_lshl_b32 s44, s20, 14
    s_lshl_b32 s45, s20, 15
    v_mfma_f32_16x16x32_bf16 a[0:3], v[192:195], v[176:179], a[0:3]
    v_and_b32 v252, 15, v227
    v_lshrrev_b32 v253, 4, v227
    v_mfma_f32_16x16x32_bf16 a[64:67], v[192:195], v[184:187], a[64:67]
    ds_read_b64_tr_b16 v[192:193], v232 offset:49152
    ds_read_b64_tr_b16 v[194:195], v232 offset:57344
    v_mul_u32_u24 v252, 144, v252
    v_lshl_add_u32 v252, v253, 3, v252
    v_mfma_f32_16x16x32_bf16 v[4:7], v[196:199], v[160:163], v[4:7]
    v_add_u32 v224, s44, v252
    v_lshrrev_b32 v252, 3, v227
    v_mfma_f32_16x16x32_bf16 v[68:71], v[196:199], v[168:171], v[68:71]
    v_and_b32 v253, 7, v227
    v_lshlrev_b32 v253, 4, v253
    v_mfma_f32_16x16x32_bf16 a[4:7], v[196:199], v[176:179], a[4:7]
    v_mul_u32_u24 v225, 144, v252
    v_add3_u32 v225, v225, v253, s44
    v_mfma_f32_16x16x32_bf16 a[68:71], v[196:199], v[184:187], a[68:71]
    ds_read_b64_tr_b16 v[196:197], v233 offset:49152
    v_lshl_add_u32 v226, v252, 9, v253
    v_add_u32 v226, s45, v226
    s_waitcnt lgkmcnt(3)
    v_mfma_f32_16x16x32_bf16 v[8:11], v[200:203], v[160:163], v[8:11]
    ds_read_b64_tr_b16 v[198:199], v233 offset:57344
    s_mov_b32 s36, 0
    s_mov_b32 s37, 4096
    v_mfma_f32_16x16x32_bf16 v[72:75], v[200:203], v[168:171], v[72:75]
    s_mov_b32 s38, 8192
    s_mov_b32 s39, 12288
    v_mfma_f32_16x16x32_bf16 a[8:11], v[200:203], v[176:179], a[8:11]
    s_mov_b32 s40, 16384
    s_mov_b32 s41, 20480
    v_mfma_f32_16x16x32_bf16 a[72:75], v[200:203], v[184:187], a[72:75]
    ds_read_b64_tr_b16 v[200:201], v234 offset:49152
    ds_read_b64_tr_b16 v[202:203], v234 offset:57344
    s_mov_b32 s42, 24576
    s_mov_b32 s43, 28672
    v_mfma_f32_16x16x32_bf16 v[12:15], v[204:207], v[160:163], v[12:15]
    v_mov_b32 v254, v244
    v_mov_b32 v255, v254
    v_mfma_f32_16x16x32_bf16 v[76:79], v[204:207], v[168:171], v[76:79]
    s_nop 0
    v_permlane32_swap_b32 v254, v255
    v_add_f32 v254, v254, v255
    v_mfma_f32_16x16x32_bf16 a[12:15], v[204:207], v[176:179], a[12:15]
    v_mov_b32 v255, v254
    s_nop 1
    v_permlane16_swap_b32 v254, v255
    v_mfma_f32_16x16x32_bf16 a[76:79], v[204:207], v[184:187], a[76:79]
    ds_read_b64_tr_b16 v[204:205], v235 offset:49152
    v_add_f32 v254, v254, v255
    s_waitcnt lgkmcnt(3)
    v_mfma_f32_16x16x32_bf16 v[16:19], v[192:195], v[160:163], v[16:19]
    ds_read_b64_tr_b16 v[206:207], v235 offset:57344
    v_rcp_f32 v236, v254
    v_mfma_f32_16x16x32_bf16 v[80:83], v[192:195], v[168:171], v[80:83]
    v_mov_b32 v254, v245
    v_mov_b32 v255, v254
    v_mfma_f32_16x16x32_bf16 a[16:19], v[192:195], v[176:179], a[16:19]
    s_nop 0
    v_permlane32_swap_b32 v254, v255
    v_add_f32 v254, v254, v255
    v_mfma_f32_16x16x32_bf16 a[80:83], v[192:195], v[184:187], a[80:83]
    ds_read_b64_tr_b16 v[192:193], v228 offset:49408
    ds_read_b64_tr_b16 v[194:195], v228 offset:57600
    v_mov_b32 v255, v254
    s_nop 1
    v_permlane16_swap_b32 v254, v255
    v_mfma_f32_16x16x32_bf16 v[20:23], v[196:199], v[160:163], v[20:23]
    v_add_f32 v254, v254, v255
    v_mfma_f32_16x16x32_bf16 v[84:87], v[196:199], v[168:171], v[84:87]
    v_rcp_f32 v238, v254
    v_mfma_f32_16x16x32_bf16 a[20:23], v[196:199], v[176:179], a[20:23]
    v_mov_b32 v254, v246
    v_mov_b32 v255, v254
    v_mfma_f32_16x16x32_bf16 a[84:87], v[196:199], v[184:187], a[84:87]
    ds_read_b64_tr_b16 v[196:197], v229 offset:49408
    v_permlane32_swap_b32 v254, v255
    v_add_f32 v254, v254, v255
    s_waitcnt lgkmcnt(3)
    v_mfma_f32_16x16x32_bf16 v[24:27], v[200:203], v[160:163], v[24:27]
    ds_read_b64_tr_b16 v[198:199], v229 offset:57600
    v_mov_b32 v255, v254
    s_nop 1
    v_permlane16_swap_b32 v254, v255
    v_mfma_f32_16x16x32_bf16 v[88:91], v[200:203], v[168:171], v[88:91]
    v_add_f32 v254, v254, v255
    v_mfma_f32_16x16x32_bf16 a[24:27], v[200:203], v[176:179], a[24:27]
    v_rcp_f32 v240, v254
    v_mfma_f32_16x16x32_bf16 a[88:91], v[200:203], v[184:187], a[88:91]
    ds_read_b64_tr_b16 v[200:201], v230 offset:49408
    ds_read_b64_tr_b16 v[202:203], v230 offset:57600
    v_mov_b32 v254, v247
    v_mov_b32 v255, v254
    v_mfma_f32_16x16x32_bf16 v[28:31], v[204:207], v[160:163], v[28:31]
    s_nop 0
    v_permlane32_swap_b32 v254, v255
    v_add_f32 v254, v254, v255
    v_mfma_f32_16x16x32_bf16 v[92:95], v[204:207], v[168:171], v[92:95]
    v_mov_b32 v255, v254
    s_nop 1
    v_permlane16_swap_b32 v254, v255
    v_mfma_f32_16x16x32_bf16 a[28:31], v[204:207], v[176:179], a[28:31]
    v_add_f32 v254, v254, v255
    v_mfma_f32_16x16x32_bf16 a[92:95], v[204:207], v[184:187], a[92:95]
    ds_read_b64_tr_b16 v[204:205], v231 offset:49408
    v_rcp_f32 v242, v254
    s_waitcnt lgkmcnt(3)
    v_mfma_f32_16x16x32_bf16 v[32:35], v[192:195], v[160:163], v[32:35]
    ds_read_b64_tr_b16 v[206:207], v231 offset:57600
    v_mul_f32 v0, v0, v236
    v_mul_f32 v1, v1, v236
    v_mfma_f32_16x16x32_bf16 v[96:99], v[192:195], v[168:171], v[96:99]
    v_mul_f32 v2, v2, v236
    v_mul_f32 v3, v3, v236
    v_mfma_f32_16x16x32_bf16 a[32:35], v[192:195], v[176:179], a[32:35]
    v_mul_f32 v4, v4, v236
    v_mul_f32 v5, v5, v236
    v_mfma_f32_16x16x32_bf16 a[96:99], v[192:195], v[184:187], a[96:99]
    ds_read_b64_tr_b16 v[192:193], v232 offset:49408
    ds_read_b64_tr_b16 v[194:195], v232 offset:57600
    v_mul_f32 v6, v6, v236
    v_mul_f32 v7, v7, v236
    v_mfma_f32_16x16x32_bf16 v[36:39], v[196:199], v[160:163], v[36:39]
    v_mul_f32 v8, v8, v236
    v_mul_f32 v9, v9, v236
    v_mfma_f32_16x16x32_bf16 v[100:103], v[196:199], v[168:171], v[100:103]
    v_mul_f32 v10, v10, v236
    v_mul_f32 v11, v11, v236
    v_mfma_f32_16x16x32_bf16 a[36:39], v[196:199], v[176:179], a[36:39]
    v_mul_f32 v12, v12, v236
    v_mul_f32 v13, v13, v236
    v_mfma_f32_16x16x32_bf16 a[100:103], v[196:199], v[184:187], a[100:103]
    ds_read_b64_tr_b16 v[196:197], v233 offset:49408
    v_mul_f32 v14, v14, v236
    v_mul_f32 v15, v15, v236
    s_waitcnt lgkmcnt(3)
    v_mfma_f32_16x16x32_bf16 v[40:43], v[200:203], v[160:163], v[40:43]
    ds_read_b64_tr_b16 v[198:199], v233 offset:57600
    v_cvt_pk_bf16_f32 v0, v0, v1
    v_cvt_pk_bf16_f32 v1, v2, v3
    v_mfma_f32_16x16x32_bf16 v[104:107], v[200:203], v[168:171], v[104:107]
    v_cvt_pk_bf16_f32 v2, v4, v5
    v_cvt_pk_bf16_f32 v3, v6, v7
    v_mfma_f32_16x16x32_bf16 a[40:43], v[200:203], v[176:179], a[40:43]
    v_cvt_pk_bf16_f32 v4, v8, v9
    v_cvt_pk_bf16_f32 v5, v10, v11
    v_mfma_f32_16x16x32_bf16 a[104:107], v[200:203], v[184:187], a[104:107]
    ds_read_b64_tr_b16 v[200:201], v234 offset:49408
    ds_read_b64_tr_b16 v[202:203], v234 offset:57600
    v_cvt_pk_bf16_f32 v6, v12, v13
    v_cvt_pk_bf16_f32 v7, v14, v15
    v_mfma_f32_16x16x32_bf16 v[44:47], v[204:207], v[160:163], v[44:47]
    ds_write_b64 v224, v[0:1] offset:0
    ds_write_b64 v224, v[2:3] offset:32
    v_mfma_f32_16x16x32_bf16 v[108:111], v[204:207], v[168:171], v[108:111]
    ds_write_b64 v224, v[4:5] offset:64
    ds_write_b64 v224, v[6:7] offset:96
    v_mfma_f32_16x16x32_bf16 a[44:47], v[204:207], v[176:179], a[44:47]
    v_mul_f32 v64, v64, v238
    v_mul_f32 v65, v65, v238
    v_mfma_f32_16x16x32_bf16 a[108:111], v[204:207], v[184:187], a[108:111]
    ds_read_b64_tr_b16 v[204:205], v235 offset:49408
    v_mul_f32 v66, v66, v238
    v_mul_f32 v67, v67, v238
    s_waitcnt lgkmcnt(7)
    v_mfma_f32_16x16x32_bf16 v[48:51], v[192:195], v[160:163], v[48:51]
    ds_read_b64_tr_b16 v[206:207], v235 offset:57600
    v_mul_f32 v68, v68, v238
    v_mul_f32 v69, v69, v238
    v_mfma_f32_16x16x32_bf16 v[112:115], v[192:195], v[168:171], v[112:115]
    v_mul_f32 v70, v70, v238
    v_mul_f32 v71, v71, v238
    v_mfma_f32_16x16x32_bf16 a[48:51], v[192:195], v[176:179], a[48:51]
    v_mul_f32 v72, v72, v238
    v_mul_f32 v73, v73, v238
    v_mfma_f32_16x16x32_bf16 a[112:115], v[192:195], v[184:187], a[112:115]
    v_mul_f32 v74, v74, v238
    v_mul_f32 v75, v75, v238
    v_mfma_f32_16x16x32_bf16 v[52:55], v[196:199], v[160:163], v[52:55]
    v_mul_f32 v76, v76, v238
    v_mul_f32 v77, v77, v238
    v_mfma_f32_16x16x32_bf16 v[116:119], v[196:199], v[168:171], v[116:119]
    v_mul_f32 v78, v78, v238
    v_mul_f32 v79, v79, v238
    v_mfma_f32_16x16x32_bf16 a[52:55], v[196:199], v[176:179], a[52:55]
    v_cvt_pk_bf16_f32 v64, v64, v65
    v_cvt_pk_bf16_f32 v65, v66, v67
    v_mfma_f32_16x16x32_bf16 a[116:119], v[196:199], v[184:187], a[116:119]
    v_cvt_pk_bf16_f32 v66, v68, v69
    v_cvt_pk_bf16_f32 v67, v70, v71
    s_waitcnt lgkmcnt(0)
    v_mfma_f32_16x16x32_bf16 v[56:59], v[200:203], v[160:163], v[56:59]
    v_cvt_pk_bf16_f32 v68, v72, v73
    v_cvt_pk_bf16_f32 v69, v74, v75
    v_mfma_f32_16x16x32_bf16 v[120:123], v[200:203], v[168:171], v[120:123]
    v_cvt_pk_bf16_f32 v70, v76, v77
    v_cvt_pk_bf16_f32 v71, v78, v79
    v_mfma_f32_16x16x32_bf16 a[56:59], v[200:203], v[176:179], a[56:59]
    ds_write_b64 v224, v[64:65] offset:2304
    ds_write_b64 v224, v[66:67] offset:2336
    v_mfma_f32_16x16x32_bf16 a[120:123], v[200:203], v[184:187], a[120:123]
    ds_write_b64 v224, v[68:69] offset:2368
    ds_write_b64 v224, v[70:71] offset:2400
    v_mfma_f32_16x16x32_bf16 v[60:63], v[204:207], v[160:163], v[60:63]
    ds_read_b128 v[8:11], v225 offset:0
    ds_read_b128 v[12:15], v225 offset:1152
    v_mfma_f32_16x16x32_bf16 v[124:127], v[204:207], v[168:171], v[124:127]
    ds_read_b128 v[72:75], v225 offset:2304
    ds_read_b128 v[76:79], v225 offset:3456
    v_mfma_f32_16x16x32_bf16 a[60:63], v[204:207], v[176:179], a[60:63]
    v_accvgpr_read_b32 v128, a0
    v_accvgpr_read_b32 v129, a1
    v_mfma_f32_16x16x32_bf16 a[124:127], v[204:207], v[184:187], a[124:127]
    v_accvgpr_read_b32 v130, a2
    v_accvgpr_read_b32 v131, a3
    v_accvgpr_read_b32 v132, a4
    v_accvgpr_read_b32 v133, a5
    v_accvgpr_read_b32 v134, a6
    v_accvgpr_read_b32 v135, a7
    v_accvgpr_read_b32 v136, a8
    v_accvgpr_read_b32 v137, a9
    v_accvgpr_read_b32 v138, a10
    v_accvgpr_read_b32 v139, a11
    v_accvgpr_read_b32 v140, a12
    v_accvgpr_read_b32 v141, a13
    v_accvgpr_read_b32 v142, a14
    v_accvgpr_read_b32 v143, a15
    v_mul_f32 v128, v128, v240
    v_mul_f32 v129, v129, v240
    v_mul_f32 v130, v130, v240
    v_mul_f32 v131, v131, v240
    v_mul_f32 v132, v132, v240
    v_mul_f32 v133, v133, v240
    v_mul_f32 v134, v134, v240
    v_mul_f32 v135, v135, v240
    v_mul_f32 v136, v136, v240
    v_mul_f32 v137, v137, v240
    v_mul_f32 v138, v138, v240
    v_mul_f32 v139, v139, v240
    v_mul_f32 v140, v140, v240
    v_mul_f32 v141, v141, v240
    v_mul_f32 v142, v142, v240
    v_mul_f32 v143, v143, v240
    v_cvt_pk_bf16_f32 v128, v128, v129
    v_cvt_pk_bf16_f32 v129, v130, v131
    v_cvt_pk_bf16_f32 v130, v132, v133
    v_cvt_pk_bf16_f32 v131, v134, v135
    v_cvt_pk_bf16_f32 v132, v136, v137
    v_cvt_pk_bf16_f32 v133, v138, v139
    v_cvt_pk_bf16_f32 v134, v140, v141
    v_cvt_pk_bf16_f32 v135, v142, v143
    ds_write_b64 v224, v[128:129] offset:4608
    ds_write_b64 v224, v[130:131] offset:4640
    ds_write_b64 v224, v[132:133] offset:4672
    ds_write_b64 v224, v[134:135] offset:4704
    s_waitcnt lgkmcnt(7)
    buffer_store_dwordx4 v[8:11], v226, s[16:19], s36 offen offset:0 nt
    s_waitcnt lgkmcnt(6)
    buffer_store_dwordx4 v[12:15], v226, s[16:19], s37 offen offset:0 nt
    s_waitcnt lgkmcnt(5)
    buffer_store_dwordx4 v[72:75], v226, s[16:19], s38 offen offset:0 nt
    s_waitcnt lgkmcnt(4)
    buffer_store_dwordx4 v[76:79], v226, s[16:19], s39 offen offset:0 nt
    v_accvgpr_read_b32 v144, a64
    v_accvgpr_read_b32 v145, a65
    v_accvgpr_read_b32 v146, a66
    v_accvgpr_read_b32 v147, a67
    v_accvgpr_read_b32 v148, a68
    v_accvgpr_read_b32 v149, a69
    v_accvgpr_read_b32 v150, a70
    v_accvgpr_read_b32 v151, a71
    v_accvgpr_read_b32 v152, a72
    v_accvgpr_read_b32 v153, a73
    v_accvgpr_read_b32 v154, a74
    v_accvgpr_read_b32 v155, a75
    v_accvgpr_read_b32 v156, a76
    v_accvgpr_read_b32 v157, a77
    v_accvgpr_read_b32 v158, a78
    v_accvgpr_read_b32 v159, a79
    v_mul_f32 v144, v144, v242
    v_mul_f32 v145, v145, v242
    v_mul_f32 v146, v146, v242
    v_mul_f32 v147, v147, v242
    v_mul_f32 v148, v148, v242
    v_mul_f32 v149, v149, v242
    v_mul_f32 v150, v150, v242
    v_mul_f32 v151, v151, v242
    v_mul_f32 v152, v152, v242
    v_mul_f32 v153, v153, v242
    v_mul_f32 v154, v154, v242
    v_mul_f32 v155, v155, v242
    v_mul_f32 v156, v156, v242
    v_mul_f32 v157, v157, v242
    v_mul_f32 v158, v158, v242
    v_mul_f32 v159, v159, v242
    v_cvt_pk_bf16_f32 v144, v144, v145
    v_cvt_pk_bf16_f32 v145, v146, v147
    v_cvt_pk_bf16_f32 v146, v148, v149
    v_cvt_pk_bf16_f32 v147, v150, v151
    v_cvt_pk_bf16_f32 v148, v152, v153
    v_cvt_pk_bf16_f32 v149, v154, v155
    v_cvt_pk_bf16_f32 v150, v156, v157
    v_cvt_pk_bf16_f32 v151, v158, v159
    ds_write_b64 v224, v[144:145] offset:6912
    ds_write_b64 v224, v[146:147] offset:6944
    ds_write_b64 v224, v[148:149] offset:6976
    ds_write_b64 v224, v[150:151] offset:7008
    ds_read_b128 v[136:139], v225 offset:4608
    ds_read_b128 v[140:143], v225 offset:5760
    ds_read_b128 v[152:155], v225 offset:6912
    ds_read_b128 v[156:159], v225 offset:8064
    v_mul_f32 v16, v16, v236
    v_mul_f32 v17, v17, v236
    v_mul_f32 v18, v18, v236
    v_mul_f32 v19, v19, v236
    v_mul_f32 v20, v20, v236
    v_mul_f32 v21, v21, v236
    v_mul_f32 v22, v22, v236
    v_mul_f32 v23, v23, v236
    v_mul_f32 v24, v24, v236
    v_mul_f32 v25, v25, v236
    v_mul_f32 v26, v26, v236
    v_mul_f32 v27, v27, v236
    v_mul_f32 v28, v28, v236
    v_mul_f32 v29, v29, v236
    v_mul_f32 v30, v30, v236
    v_mul_f32 v31, v31, v236
    v_cvt_pk_bf16_f32 v16, v16, v17
    v_cvt_pk_bf16_f32 v17, v18, v19
    v_cvt_pk_bf16_f32 v18, v20, v21
    v_cvt_pk_bf16_f32 v19, v22, v23
    v_cvt_pk_bf16_f32 v20, v24, v25
    v_cvt_pk_bf16_f32 v21, v26, v27
    v_cvt_pk_bf16_f32 v22, v28, v29
    v_cvt_pk_bf16_f32 v23, v30, v31
    ds_write_b64 v224, v[16:17] offset:9216
    ds_write_b64 v224, v[18:19] offset:9248
    ds_write_b64 v224, v[20:21] offset:9280
    ds_write_b64 v224, v[22:23] offset:9312
    s_waitcnt lgkmcnt(7)
    buffer_store_dwordx4 v[136:139], v226, s[16:19], s40 offen offset:0 nt
    s_waitcnt lgkmcnt(6)
    buffer_store_dwordx4 v[140:143], v226, s[16:19], s41 offen offset:0 nt
    s_waitcnt lgkmcnt(5)
    buffer_store_dwordx4 v[152:155], v226, s[16:19], s42 offen offset:0 nt
    s_waitcnt lgkmcnt(4)
    buffer_store_dwordx4 v[156:159], v226, s[16:19], s43 offen offset:0 nt
    v_mul_f32 v80, v80, v238
    v_mul_f32 v81, v81, v238
    v_mul_f32 v82, v82, v238
    v_mul_f32 v83, v83, v238
    v_mul_f32 v84, v84, v238
    v_mul_f32 v85, v85, v238
    v_mul_f32 v86, v86, v238
    v_mul_f32 v87, v87, v238
    v_mul_f32 v88, v88, v238
    v_mul_f32 v89, v89, v238
    v_mul_f32 v90, v90, v238
    v_mul_f32 v91, v91, v238
    v_mul_f32 v92, v92, v238
    v_mul_f32 v93, v93, v238
    v_mul_f32 v94, v94, v238
    v_mul_f32 v95, v95, v238
    v_cvt_pk_bf16_f32 v80, v80, v81
    v_cvt_pk_bf16_f32 v81, v82, v83
    v_cvt_pk_bf16_f32 v82, v84, v85
    v_cvt_pk_bf16_f32 v83, v86, v87
    v_cvt_pk_bf16_f32 v84, v88, v89
    v_cvt_pk_bf16_f32 v85, v90, v91
    v_cvt_pk_bf16_f32 v86, v92, v93
    v_cvt_pk_bf16_f32 v87, v94, v95
    ds_write_b64 v224, v[80:81] offset:11520
    ds_write_b64 v224, v[82:83] offset:11552
    ds_write_b64 v224, v[84:85] offset:11584
    ds_write_b64 v224, v[86:87] offset:11616
    ds_read_b128 v[24:27], v225 offset:9216
    ds_read_b128 v[28:31], v225 offset:10368
    ds_read_b128 v[88:91], v225 offset:11520
    ds_read_b128 v[92:95], v225 offset:12672
    v_accvgpr_read_b32 v128, a16
    v_accvgpr_read_b32 v129, a17
    v_accvgpr_read_b32 v130, a18
    v_accvgpr_read_b32 v131, a19
    v_accvgpr_read_b32 v132, a20
    v_accvgpr_read_b32 v133, a21
    v_accvgpr_read_b32 v134, a22
    v_accvgpr_read_b32 v135, a23
    v_accvgpr_read_b32 v136, a24
    v_accvgpr_read_b32 v137, a25
    v_accvgpr_read_b32 v138, a26
    v_accvgpr_read_b32 v139, a27
    v_accvgpr_read_b32 v140, a28
    v_accvgpr_read_b32 v141, a29
    v_accvgpr_read_b32 v142, a30
    v_accvgpr_read_b32 v143, a31
    v_mul_f32 v128, v128, v240
    v_mul_f32 v129, v129, v240
    v_mul_f32 v130, v130, v240
    v_mul_f32 v131, v131, v240
    v_mul_f32 v132, v132, v240
    v_mul_f32 v133, v133, v240
    v_mul_f32 v134, v134, v240
    v_mul_f32 v135, v135, v240
    v_mul_f32 v136, v136, v240
    v_mul_f32 v137, v137, v240
    v_mul_f32 v138, v138, v240
    v_mul_f32 v139, v139, v240
    v_mul_f32 v140, v140, v240
    v_mul_f32 v141, v141, v240
    v_mul_f32 v142, v142, v240
    v_mul_f32 v143, v143, v240
    v_cvt_pk_bf16_f32 v128, v128, v129
    v_cvt_pk_bf16_f32 v129, v130, v131
    v_cvt_pk_bf16_f32 v130, v132, v133
    v_cvt_pk_bf16_f32 v131, v134, v135
    v_cvt_pk_bf16_f32 v132, v136, v137
    v_cvt_pk_bf16_f32 v133, v138, v139
    v_cvt_pk_bf16_f32 v134, v140, v141
    v_cvt_pk_bf16_f32 v135, v142, v143
    ds_write_b64 v224, v[128:129] offset:0
    ds_write_b64 v224, v[130:131] offset:32
    ds_write_b64 v224, v[132:133] offset:64
    ds_write_b64 v224, v[134:135] offset:96
    s_waitcnt lgkmcnt(7)
    buffer_store_dwordx4 v[24:27], v226, s[16:19], s36 offen offset:128 nt
    s_waitcnt lgkmcnt(6)
    buffer_store_dwordx4 v[28:31], v226, s[16:19], s37 offen offset:128 nt
    s_waitcnt lgkmcnt(5)
    buffer_store_dwordx4 v[88:91], v226, s[16:19], s38 offen offset:128 nt
    s_waitcnt lgkmcnt(4)
    buffer_store_dwordx4 v[92:95], v226, s[16:19], s39 offen offset:128 nt
    v_accvgpr_read_b32 v144, a80
    v_accvgpr_read_b32 v145, a81
    v_accvgpr_read_b32 v146, a82
    v_accvgpr_read_b32 v147, a83
    v_accvgpr_read_b32 v148, a84
    v_accvgpr_read_b32 v149, a85
    v_accvgpr_read_b32 v150, a86
    v_accvgpr_read_b32 v151, a87
    v_accvgpr_read_b32 v152, a88
    v_accvgpr_read_b32 v153, a89
    v_accvgpr_read_b32 v154, a90
    v_accvgpr_read_b32 v155, a91
    v_accvgpr_read_b32 v156, a92
    v_accvgpr_read_b32 v157, a93
    v_accvgpr_read_b32 v158, a94
    v_accvgpr_read_b32 v159, a95
    v_mul_f32 v144, v144, v242
    v_mul_f32 v145, v145, v242
    v_mul_f32 v146, v146, v242
    v_mul_f32 v147, v147, v242
    v_mul_f32 v148, v148, v242
    v_mul_f32 v149, v149, v242
    v_mul_f32 v150, v150, v242
    v_mul_f32 v151, v151, v242
    v_mul_f32 v152, v152, v242
    v_mul_f32 v153, v153, v242
    v_mul_f32 v154, v154, v242
    v_mul_f32 v155, v155, v242
    v_mul_f32 v156, v156, v242
    v_mul_f32 v157, v157, v242
    v_mul_f32 v158, v158, v242
    v_mul_f32 v159, v159, v242
    v_cvt_pk_bf16_f32 v144, v144, v145
    v_cvt_pk_bf16_f32 v145, v146, v147
    v_cvt_pk_bf16_f32 v146, v148, v149
    v_cvt_pk_bf16_f32 v147, v150, v151
    v_cvt_pk_bf16_f32 v148, v152, v153
    v_cvt_pk_bf16_f32 v149, v154, v155
    v_cvt_pk_bf16_f32 v150, v156, v157
    v_cvt_pk_bf16_f32 v151, v158, v159
    ds_write_b64 v224, v[144:145] offset:2304
    ds_write_b64 v224, v[146:147] offset:2336
    ds_write_b64 v224, v[148:149] offset:2368
    ds_write_b64 v224, v[150:151] offset:2400
    ds_read_b128 v[136:139], v225 offset:0
    ds_read_b128 v[140:143], v225 offset:1152
    ds_read_b128 v[152:155], v225 offset:2304
    ds_read_b128 v[156:159], v225 offset:3456
    v_pk_mul_f32 v[32:33], v[32:33], v[236:237] op_sel_hi:[1,0]
    v_pk_mul_f32 v[34:35], v[34:35], v[236:237] op_sel_hi:[1,0]
    v_pk_mul_f32 v[36:37], v[36:37], v[236:237] op_sel_hi:[1,0]
    v_pk_mul_f32 v[38:39], v[38:39], v[236:237] op_sel_hi:[1,0]
    v_pk_mul_f32 v[40:41], v[40:41], v[236:237] op_sel_hi:[1,0]
    v_pk_mul_f32 v[42:43], v[42:43], v[236:237] op_sel_hi:[1,0]
    v_pk_mul_f32 v[44:45], v[44:45], v[236:237] op_sel_hi:[1,0]
    v_pk_mul_f32 v[46:47], v[46:47], v[236:237] op_sel_hi:[1,0]
    v_cvt_pk_bf16_f32 v32, v32, v33
    v_cvt_pk_bf16_f32 v33, v34, v35
    v_cvt_pk_bf16_f32 v34, v36, v37
    v_cvt_pk_bf16_f32 v35, v38, v39
    v_cvt_pk_bf16_f32 v36, v40, v41
    v_cvt_pk_bf16_f32 v37, v42, v43
    v_cvt_pk_bf16_f32 v38, v44, v45
    v_cvt_pk_bf16_f32 v39, v46, v47
    ds_write_b64 v224, v[32:33] offset:4608
    ds_write_b64 v224, v[34:35] offset:4640
    ds_write_b64 v224, v[36:37] offset:4672
    ds_write_b64 v224, v[38:39] offset:4704
    s_waitcnt lgkmcnt(7)
    buffer_store_dwordx4 v[136:139], v226, s[16:19], s40 offen offset:128 nt
    s_waitcnt lgkmcnt(6)
    buffer_store_dwordx4 v[140:143], v226, s[16:19], s41 offen offset:128 nt
    s_waitcnt lgkmcnt(5)
    buffer_store_dwordx4 v[152:155], v226, s[16:19], s42 offen offset:128 nt
    s_waitcnt lgkmcnt(4)
    buffer_store_dwordx4 v[156:159], v226, s[16:19], s43 offen offset:128 nt
    v_pk_mul_f32 v[96:97], v[96:97], v[238:239] op_sel_hi:[1,0]
    v_pk_mul_f32 v[98:99], v[98:99], v[238:239] op_sel_hi:[1,0]
    v_pk_mul_f32 v[100:101], v[100:101], v[238:239] op_sel_hi:[1,0]
    v_pk_mul_f32 v[102:103], v[102:103], v[238:239] op_sel_hi:[1,0]
    v_pk_mul_f32 v[104:105], v[104:105], v[238:239] op_sel_hi:[1,0]
    v_pk_mul_f32 v[106:107], v[106:107], v[238:239] op_sel_hi:[1,0]
    v_pk_mul_f32 v[108:109], v[108:109], v[238:239] op_sel_hi:[1,0]
    v_pk_mul_f32 v[110:111], v[110:111], v[238:239] op_sel_hi:[1,0]
    v_cvt_pk_bf16_f32 v96, v96, v97
    v_cvt_pk_bf16_f32 v97, v98, v99
    v_cvt_pk_bf16_f32 v98, v100, v101
    v_cvt_pk_bf16_f32 v99, v102, v103
    v_cvt_pk_bf16_f32 v100, v104, v105
    v_cvt_pk_bf16_f32 v101, v106, v107
    v_cvt_pk_bf16_f32 v102, v108, v109
    v_cvt_pk_bf16_f32 v103, v110, v111
    ds_write_b64 v224, v[96:97] offset:6912
    ds_write_b64 v224, v[98:99] offset:6944
    ds_write_b64 v224, v[100:101] offset:6976
    ds_write_b64 v224, v[102:103] offset:7008
    ds_read_b128 v[40:43], v225 offset:4608
    ds_read_b128 v[44:47], v225 offset:5760
    ds_read_b128 v[104:107], v225 offset:6912
    ds_read_b128 v[108:111], v225 offset:8064
    v_accvgpr_read_b32 v128, a32
    v_accvgpr_read_b32 v129, a33
    v_accvgpr_read_b32 v130, a34
    v_accvgpr_read_b32 v131, a35
    v_accvgpr_read_b32 v132, a36
    v_accvgpr_read_b32 v133, a37
    v_accvgpr_read_b32 v134, a38
    v_accvgpr_read_b32 v135, a39
    v_accvgpr_read_b32 v136, a40
    v_accvgpr_read_b32 v137, a41
    v_accvgpr_read_b32 v138, a42
    v_accvgpr_read_b32 v139, a43
    v_accvgpr_read_b32 v140, a44
    v_accvgpr_read_b32 v141, a45
    v_accvgpr_read_b32 v142, a46
    v_accvgpr_read_b32 v143, a47
    v_pk_mul_f32 v[128:129], v[128:129], v[240:241] op_sel_hi:[1,0]
    v_pk_mul_f32 v[130:131], v[130:131], v[240:241] op_sel_hi:[1,0]
    v_pk_mul_f32 v[132:133], v[132:133], v[240:241] op_sel_hi:[1,0]
    v_pk_mul_f32 v[134:135], v[134:135], v[240:241] op_sel_hi:[1,0]
    v_pk_mul_f32 v[136:137], v[136:137], v[240:241] op_sel_hi:[1,0]
    v_pk_mul_f32 v[138:139], v[138:139], v[240:241] op_sel_hi:[1,0]
    v_pk_mul_f32 v[140:141], v[140:141], v[240:241] op_sel_hi:[1,0]
    v_pk_mul_f32 v[142:143], v[142:143], v[240:241] op_sel_hi:[1,0]
    v_cvt_pk_bf16_f32 v128, v128, v129
    v_cvt_pk_bf16_f32 v129, v130, v131
    v_cvt_pk_bf16_f32 v130, v132, v133
    v_cvt_pk_bf16_f32 v131, v134, v135
    v_cvt_pk_bf16_f32 v132, v136, v137
    v_cvt_pk_bf16_f32 v133, v138, v139
    v_cvt_pk_bf16_f32 v134, v140, v141
    v_cvt_pk_bf16_f32 v135, v142, v143
    ds_write_b64 v224, v[128:129] offset:9216
    ds_write_b64 v224, v[130:131] offset:9248
    ds_write_b64 v224, v[132:133] offset:9280
    ds_write_b64 v224, v[134:135] offset:9312
    s_waitcnt lgkmcnt(7)
    buffer_store_dwordx4 v[40:43], v226, s[16:19], s36 offen offset:256 nt
    s_waitcnt lgkmcnt(6)
    buffer_store_dwordx4 v[44:47], v226, s[16:19], s37 offen offset:256 nt
    s_waitcnt lgkmcnt(5)
    buffer_store_dwordx4 v[104:107], v226, s[16:19], s38 offen offset:256 nt
    s_waitcnt lgkmcnt(4)
    buffer_store_dwordx4 v[108:111], v226, s[16:19], s39 offen offset:256 nt
    v_accvgpr_read_b32 v144, a96
    v_accvgpr_read_b32 v145, a97
    v_accvgpr_read_b32 v146, a98
    v_accvgpr_read_b32 v147, a99
    v_accvgpr_read_b32 v148, a100
    v_accvgpr_read_b32 v149, a101
    v_accvgpr_read_b32 v150, a102
    v_accvgpr_read_b32 v151, a103
    v_accvgpr_read_b32 v152, a104
    v_accvgpr_read_b32 v153, a105
    v_accvgpr_read_b32 v154, a106
    v_accvgpr_read_b32 v155, a107
    v_accvgpr_read_b32 v156, a108
    v_accvgpr_read_b32 v157, a109
    v_accvgpr_read_b32 v158, a110
    v_accvgpr_read_b32 v159, a111
    v_pk_mul_f32 v[144:145], v[144:145], v[242:243] op_sel_hi:[1,0]
    v_pk_mul_f32 v[146:147], v[146:147], v[242:243] op_sel_hi:[1,0]
    v_pk_mul_f32 v[148:149], v[148:149], v[242:243] op_sel_hi:[1,0]
    v_pk_mul_f32 v[150:151], v[150:151], v[242:243] op_sel_hi:[1,0]
    v_pk_mul_f32 v[152:153], v[152:153], v[242:243] op_sel_hi:[1,0]
    v_pk_mul_f32 v[154:155], v[154:155], v[242:243] op_sel_hi:[1,0]
    v_pk_mul_f32 v[156:157], v[156:157], v[242:243] op_sel_hi:[1,0]
    v_pk_mul_f32 v[158:159], v[158:159], v[242:243] op_sel_hi:[1,0]
    v_cvt_pk_bf16_f32 v144, v144, v145
    v_cvt_pk_bf16_f32 v145, v146, v147
    v_cvt_pk_bf16_f32 v146, v148, v149
    v_cvt_pk_bf16_f32 v147, v150, v151
    v_cvt_pk_bf16_f32 v148, v152, v153
    v_cvt_pk_bf16_f32 v149, v154, v155
    v_cvt_pk_bf16_f32 v150, v156, v157
    v_cvt_pk_bf16_f32 v151, v158, v159
    ds_write_b64 v224, v[144:145] offset:11520
    ds_write_b64 v224, v[146:147] offset:11552
    ds_write_b64 v224, v[148:149] offset:11584
    ds_write_b64 v224, v[150:151] offset:11616
    ds_read_b128 v[136:139], v225 offset:9216
    ds_read_b128 v[140:143], v225 offset:10368
    ds_read_b128 v[152:155], v225 offset:11520
    ds_read_b128 v[156:159], v225 offset:12672
    v_pk_mul_f32 v[48:49], v[48:49], v[236:237] op_sel_hi:[1,0]
    v_pk_mul_f32 v[50:51], v[50:51], v[236:237] op_sel_hi:[1,0]
    v_pk_mul_f32 v[52:53], v[52:53], v[236:237] op_sel_hi:[1,0]
    v_pk_mul_f32 v[54:55], v[54:55], v[236:237] op_sel_hi:[1,0]
    v_pk_mul_f32 v[56:57], v[56:57], v[236:237] op_sel_hi:[1,0]
    v_pk_mul_f32 v[58:59], v[58:59], v[236:237] op_sel_hi:[1,0]
    v_pk_mul_f32 v[60:61], v[60:61], v[236:237] op_sel_hi:[1,0]
    v_pk_mul_f32 v[62:63], v[62:63], v[236:237] op_sel_hi:[1,0]
    v_cvt_pk_bf16_f32 v48, v48, v49
    v_cvt_pk_bf16_f32 v49, v50, v51
    v_cvt_pk_bf16_f32 v50, v52, v53
    v_cvt_pk_bf16_f32 v51, v54, v55
    v_cvt_pk_bf16_f32 v52, v56, v57
    v_cvt_pk_bf16_f32 v53, v58, v59
    v_cvt_pk_bf16_f32 v54, v60, v61
    v_cvt_pk_bf16_f32 v55, v62, v63
    ds_write_b64 v224, v[48:49] offset:0
    ds_write_b64 v224, v[50:51] offset:32
    ds_write_b64 v224, v[52:53] offset:64
    ds_write_b64 v224, v[54:55] offset:96
    s_waitcnt lgkmcnt(7)
    buffer_store_dwordx4 v[136:139], v226, s[16:19], s40 offen offset:256 nt
    s_waitcnt lgkmcnt(6)
    buffer_store_dwordx4 v[140:143], v226, s[16:19], s41 offen offset:256 nt
    s_waitcnt lgkmcnt(5)
    buffer_store_dwordx4 v[152:155], v226, s[16:19], s42 offen offset:256 nt
    s_waitcnt lgkmcnt(4)
    buffer_store_dwordx4 v[156:159], v226, s[16:19], s43 offen offset:256 nt
    v_pk_mul_f32 v[112:113], v[112:113], v[238:239] op_sel_hi:[1,0]
    v_pk_mul_f32 v[114:115], v[114:115], v[238:239] op_sel_hi:[1,0]
    v_pk_mul_f32 v[116:117], v[116:117], v[238:239] op_sel_hi:[1,0]
    v_pk_mul_f32 v[118:119], v[118:119], v[238:239] op_sel_hi:[1,0]
    v_pk_mul_f32 v[120:121], v[120:121], v[238:239] op_sel_hi:[1,0]
    v_pk_mul_f32 v[122:123], v[122:123], v[238:239] op_sel_hi:[1,0]
    v_pk_mul_f32 v[124:125], v[124:125], v[238:239] op_sel_hi:[1,0]
    v_pk_mul_f32 v[126:127], v[126:127], v[238:239] op_sel_hi:[1,0]
    v_cvt_pk_bf16_f32 v112, v112, v113
    v_cvt_pk_bf16_f32 v113, v114, v115
    v_cvt_pk_bf16_f32 v114, v116, v117
    v_cvt_pk_bf16_f32 v115, v118, v119
    v_cvt_pk_bf16_f32 v116, v120, v121
    v_cvt_pk_bf16_f32 v117, v122, v123
    v_cvt_pk_bf16_f32 v118, v124, v125
    v_cvt_pk_bf16_f32 v119, v126, v127
    ds_write_b64 v224, v[112:113] offset:2304
    ds_write_b64 v224, v[114:115] offset:2336
    ds_write_b64 v224, v[116:117] offset:2368
    ds_write_b64 v224, v[118:119] offset:2400
    ds_read_b128 v[56:59], v225 offset:0
    ds_read_b128 v[60:63], v225 offset:1152
    ds_read_b128 v[120:123], v225 offset:2304
    ds_read_b128 v[124:127], v225 offset:3456
    v_accvgpr_read_b32 v128, a48
    v_accvgpr_read_b32 v129, a49
    v_accvgpr_read_b32 v130, a50
    v_accvgpr_read_b32 v131, a51
    v_accvgpr_read_b32 v132, a52
    v_accvgpr_read_b32 v133, a53
    v_accvgpr_read_b32 v134, a54
    v_accvgpr_read_b32 v135, a55
    v_accvgpr_read_b32 v136, a56
    v_accvgpr_read_b32 v137, a57
    v_accvgpr_read_b32 v138, a58
    v_accvgpr_read_b32 v139, a59
    v_accvgpr_read_b32 v140, a60
    v_accvgpr_read_b32 v141, a61
    v_accvgpr_read_b32 v142, a62
    v_accvgpr_read_b32 v143, a63
    v_pk_mul_f32 v[128:129], v[128:129], v[240:241] op_sel_hi:[1,0]
    v_pk_mul_f32 v[130:131], v[130:131], v[240:241] op_sel_hi:[1,0]
    v_pk_mul_f32 v[132:133], v[132:133], v[240:241] op_sel_hi:[1,0]
    v_pk_mul_f32 v[134:135], v[134:135], v[240:241] op_sel_hi:[1,0]
    v_pk_mul_f32 v[136:137], v[136:137], v[240:241] op_sel_hi:[1,0]
    v_pk_mul_f32 v[138:139], v[138:139], v[240:241] op_sel_hi:[1,0]
    v_pk_mul_f32 v[140:141], v[140:141], v[240:241] op_sel_hi:[1,0]
    v_pk_mul_f32 v[142:143], v[142:143], v[240:241] op_sel_hi:[1,0]
    v_cvt_pk_bf16_f32 v128, v128, v129
    v_cvt_pk_bf16_f32 v129, v130, v131
    v_cvt_pk_bf16_f32 v130, v132, v133
    v_cvt_pk_bf16_f32 v131, v134, v135
    v_cvt_pk_bf16_f32 v132, v136, v137
    v_cvt_pk_bf16_f32 v133, v138, v139
    v_cvt_pk_bf16_f32 v134, v140, v141
    v_cvt_pk_bf16_f32 v135, v142, v143
    ds_write_b64 v224, v[128:129] offset:4608
    ds_write_b64 v224, v[130:131] offset:4640
    ds_write_b64 v224, v[132:133] offset:4672
    ds_write_b64 v224, v[134:135] offset:4704
    s_waitcnt lgkmcnt(7)
    buffer_store_dwordx4 v[56:59], v226, s[16:19], s36 offen offset:384 nt
    s_waitcnt lgkmcnt(6)
    buffer_store_dwordx4 v[60:63], v226, s[16:19], s37 offen offset:384 nt
    s_waitcnt lgkmcnt(5)
    buffer_store_dwordx4 v[120:123], v226, s[16:19], s38 offen offset:384 nt
    s_waitcnt lgkmcnt(4)
    buffer_store_dwordx4 v[124:127], v226, s[16:19], s39 offen offset:384 nt
    v_accvgpr_read_b32 v144, a112
    v_accvgpr_read_b32 v145, a113
    v_accvgpr_read_b32 v146, a114
    v_accvgpr_read_b32 v147, a115
    v_accvgpr_read_b32 v148, a116
    v_accvgpr_read_b32 v149, a117
    v_accvgpr_read_b32 v150, a118
    v_accvgpr_read_b32 v151, a119
    v_accvgpr_read_b32 v152, a120
    v_accvgpr_read_b32 v153, a121
    v_accvgpr_read_b32 v154, a122
    v_accvgpr_read_b32 v155, a123
    v_accvgpr_read_b32 v156, a124
    v_accvgpr_read_b32 v157, a125
    v_accvgpr_read_b32 v158, a126
    v_accvgpr_read_b32 v159, a127
    v_pk_mul_f32 v[144:145], v[144:145], v[242:243] op_sel_hi:[1,0]
    v_pk_mul_f32 v[146:147], v[146:147], v[242:243] op_sel_hi:[1,0]
    v_pk_mul_f32 v[148:149], v[148:149], v[242:243] op_sel_hi:[1,0]
    v_pk_mul_f32 v[150:151], v[150:151], v[242:243] op_sel_hi:[1,0]
    v_pk_mul_f32 v[152:153], v[152:153], v[242:243] op_sel_hi:[1,0]
    v_pk_mul_f32 v[154:155], v[154:155], v[242:243] op_sel_hi:[1,0]
    v_pk_mul_f32 v[156:157], v[156:157], v[242:243] op_sel_hi:[1,0]
    v_pk_mul_f32 v[158:159], v[158:159], v[242:243] op_sel_hi:[1,0]
    v_cvt_pk_bf16_f32 v144, v144, v145
    v_cvt_pk_bf16_f32 v145, v146, v147
    v_cvt_pk_bf16_f32 v146, v148, v149
    v_cvt_pk_bf16_f32 v147, v150, v151
    v_cvt_pk_bf16_f32 v148, v152, v153
    v_cvt_pk_bf16_f32 v149, v154, v155
    v_cvt_pk_bf16_f32 v150, v156, v157
    v_cvt_pk_bf16_f32 v151, v158, v159
    ds_write_b64 v224, v[144:145] offset:6912
    ds_write_b64 v224, v[146:147] offset:6944
    ds_write_b64 v224, v[148:149] offset:6976
    ds_write_b64 v224, v[150:151] offset:7008
    ds_read_b128 v[136:139], v225 offset:4608
    ds_read_b128 v[140:143], v225 offset:5760
    ds_read_b128 v[152:155], v225 offset:6912
    ds_read_b128 v[156:159], v225 offset:8064
    s_waitcnt lgkmcnt(3)
    buffer_store_dwordx4 v[136:139], v226, s[16:19], s40 offen offset:384 nt
    s_waitcnt lgkmcnt(2)
    buffer_store_dwordx4 v[140:143], v226, s[16:19], s41 offen offset:384 nt
    s_waitcnt lgkmcnt(1)
    buffer_store_dwordx4 v[152:155], v226, s[16:19], s42 offen offset:384 nt
    s_waitcnt lgkmcnt(0)
    buffer_store_dwordx4 v[156:159], v226, s[16:19], s43 offen offset:384 nt
L_end:
    s_endpgm
L_stub_0:
    s_mov_b32 s30, 0
    s_branch L_R10
L_stub_4:
    s_mov_b32 s30, 4
    s_branch L_R10
L_stub_8:
    s_mov_b32 s30, 8
    s_branch L_R10
L_stub_12:
    s_mov_b32 s30, 12
    s_branch L_R10
L_stub_2:
    s_mov_b32 s30, 2
    s_branch L_R11
L_stub_6:
    s_mov_b32 s30, 6
    s_branch L_R11
L_stub_10:
    s_mov_b32 s30, 10
    s_branch L_R11
L_stub_14:
    s_mov_b32 s30, 14
    s_branch L_R11
L_stub_1:
    s_mov_b32 s30, 1
    s_branch L_R2
L_stub_3:
    s_mov_b32 s30, 3
    s_branch L_R2
L_stub_5:
    s_mov_b32 s30, 5
    s_branch L_R2
L_stub_7:
    s_mov_b32 s30, 7
    s_branch L_R2
L_stub_9:
    s_mov_b32 s30, 9
    s_branch L_R2
L_stub_11:
    s_mov_b32 s30, 11
    s_branch L_R2
L_stub_13:
    s_mov_b32 s30, 13
    s_branch L_R2
L_stub_15:
    s_mov_b32 s30, 15
    s_branch L_R2
L_R10:
    s_nop 11
    v_max3_f32 v254, v128, v129, v130
    v_max3_f32 v254, v254, v131, v132
    v_max3_f32 v254, v254, v133, v134
    v_max_f32 v254, v254, v135
    v_mov_b32 v255, v254
    s_nop 0
    s_nop 0
    v_permlane32_swap_b32 v254, v255
    v_max_f32 v254, v254, v255
    v_mov_b32 v255, v254
    s_nop 0
    s_nop 0
    v_permlane16_swap_b32 v254, v255
    v_max_f32 v254, v254, v255
    v_max_f32 v254, s31, v254
    v_sub_f32 v128, v128, v254
    v_sub_f32 v129, v129, v254
    v_sub_f32 v130, v130, v254
    v_sub_f32 v131, v131, v254
    v_sub_f32 v132, v132, v254
    v_sub_f32 v133, v133, v254
    v_sub_f32 v134, v134, v254
    v_sub_f32 v135, v135, v254
    v_sub_f32 v208, v208, v254
    v_sub_f32 v209, v209, v254
    v_sub_f32 v210, v210, v254
    v_sub_f32 v211, v211, v254
    v_sub_f32 v255, 0, v254
    v_min_f32 v255, 0, v255
    v_exp_f32 v255, v255
    s_nop 0
    v_mul_f32 v244, v244, v255
    v_mov_b32 v248, v255
    v_max3_f32 v254, v136, v137, v138
    v_max3_f32 v254, v254, v139, v140
    v_max3_f32 v254, v254, v141, v142
    v_max_f32 v254, v254, v143
    v_mov_b32 v255, v254
    s_nop 0
    s_nop 0
    v_permlane32_swap_b32 v254, v255
    v_max_f32 v254, v254, v255
    v_mov_b32 v255, v254
    s_nop 0
    s_nop 0
    v_permlane16_swap_b32 v254, v255
    v_max_f32 v254, v254, v255
    v_max_f32 v254, s31, v254
    v_sub_f32 v136, v136, v254
    v_sub_f32 v137, v137, v254
    v_sub_f32 v138, v138, v254
    v_sub_f32 v139, v139, v254
    v_sub_f32 v140, v140, v254
    v_sub_f32 v141, v141, v254
    v_sub_f32 v142, v142, v254
    v_sub_f32 v143, v143, v254
    v_sub_f32 v212, v212, v254
    v_sub_f32 v213, v213, v254
    v_sub_f32 v214, v214, v254
    v_sub_f32 v215, v215, v254
    v_sub_f32 v255, 0, v254
    v_min_f32 v255, 0, v255
    v_exp_f32 v255, v255
    s_nop 0
    v_mul_f32 v245, v245, v255
    v_mov_b32 v249, v255
    v_max3_f32 v254, v144, v145, v146
    v_max3_f32 v254, v254, v147, v148
    v_max3_f32 v254, v254, v149, v150
    v_max_f32 v254, v254, v151
    v_mov_b32 v255, v254
    s_nop 0
    s_nop 0
    v_permlane32_swap_b32 v254, v255
    v_max_f32 v254, v254, v255
    v_mov_b32 v255, v254
    s_nop 0
    s_nop 0
    v_permlane16_swap_b32 v254, v255
    v_max_f32 v254, v254, v255
    v_max_f32 v254, s31, v254
    v_sub_f32 v144, v144, v254
    v_sub_f32 v145, v145, v254
    v_sub_f32 v146, v146, v254
    v_sub_f32 v147, v147, v254
    v_sub_f32 v148, v148, v254
    v_sub_f32 v149, v149, v254
    v_sub_f32 v150, v150, v254
    v_sub_f32 v151, v151, v254
    v_sub_f32 v216, v216, v254
    v_sub_f32 v217, v217, v254
    v_sub_f32 v218, v218, v254
    v_sub_f32 v219, v219, v254
    v_sub_f32 v255, 0, v254
    v_min_f32 v255, 0, v255
    v_exp_f32 v255, v255
    s_nop 0
    v_mul_f32 v246, v246, v255
    v_mov_b32 v250, v255
    v_max3_f32 v254, v152, v153, v154
    v_max3_f32 v254, v254, v155, v156
    v_max3_f32 v254, v254, v157, v158
    v_max_f32 v254, v254, v159
    v_mov_b32 v255, v254
    s_nop 0
    s_nop 0
    v_permlane32_swap_b32 v254, v255
    v_max_f32 v254, v254, v255
    v_mov_b32 v255, v254
    s_nop 0
    s_nop 0
    v_permlane16_swap_b32 v254, v255
    v_max_f32 v254, v254, v255
    v_max_f32 v254, s31, v254
    v_sub_f32 v152, v152, v254
    v_sub_f32 v153, v153, v254
    v_sub_f32 v154, v154, v254
    v_sub_f32 v155, v155, v254
    v_sub_f32 v156, v156, v254
    v_sub_f32 v157, v157, v254
    v_sub_f32 v158, v158, v254
    v_sub_f32 v159, v159, v254
    v_sub_f32 v220, v220, v254
    v_sub_f32 v221, v221, v254
    v_sub_f32 v222, v222, v254
    v_sub_f32 v223, v223, v254
    v_sub_f32 v255, 0, v254
    v_min_f32 v255, 0, v255
    v_exp_f32 v255, v255
    s_nop 0
    v_mul_f32 v247, v247, v255
    v_mov_b32 v251, v255
    s_mov_b32 s25, 1
    s_nop 1
    s_cmp_eq_u32 s30, 0
    s_cbranch_scc1 L_back_0
    s_cmp_eq_u32 s30, 4
    s_cbranch_scc1 L_back_4
    s_cmp_eq_u32 s30, 8
    s_cbranch_scc1 L_back_8
    s_cmp_eq_u32 s30, 12
    s_cbranch_scc1 L_back_12
    s_endpgm
L_R11:
    s_nop 11
    v_max3_f32 v254, v160, v161, v162
    v_max3_f32 v254, v254, v163, v164
    v_max3_f32 v254, v254, v165, v166
    v_max_f32 v254, v254, v167
    v_mov_b32 v255, v254
    s_nop 0
    s_nop 0
    v_permlane32_swap_b32 v254, v255
    v_max_f32 v254, v254, v255
    v_mov_b32 v255, v254
    s_nop 0
    s_nop 0
    v_permlane16_swap_b32 v254, v255
    v_max_f32 v254, v254, v255
    v_max_f32 v254, s31, v254
    v_sub_f32 v160, v160, v254
    v_sub_f32 v161, v161, v254
    v_sub_f32 v162, v162, v254
    v_sub_f32 v163, v163, v254
    v_sub_f32 v164, v164, v254
    v_sub_f32 v165, v165, v254
    v_sub_f32 v166, v166, v254
    v_sub_f32 v167, v167, v254
    v_sub_f32 v208, v208, v254
    v_sub_f32 v209, v209, v254
    v_sub_f32 v210, v210, v254
    v_sub_f32 v211, v211, v254
    v_sub_f32 v255, 0, v254
    v_min_f32 v255, 0, v255
    v_exp_f32 v255, v255
    s_nop 0
    v_mul_f32 v244, v244, v255
    v_mov_b32 v248, v255
    v_max3_f32 v254, v168, v169, v170
    v_max3_f32 v254, v254, v171, v172
    v_max3_f32 v254, v254, v173, v174
    v_max_f32 v254, v254, v175
    v_mov_b32 v255, v254
    s_nop 0
    s_nop 0
    v_permlane32_swap_b32 v254, v255
    v_max_f32 v254, v254, v255
    v_mov_b32 v255, v254
    s_nop 0
    s_nop 0
    v_permlane16_swap_b32 v254, v255
    v_max_f32 v254, v254, v255
    v_max_f32 v254, s31, v254
    v_sub_f32 v168, v168, v254
    v_sub_f32 v169, v169, v254
    v_sub_f32 v170, v170, v254
    v_sub_f32 v171, v171, v254
    v_sub_f32 v172, v172, v254
    v_sub_f32 v173, v173, v254
    v_sub_f32 v174, v174, v254
    v_sub_f32 v175, v175, v254
    v_sub_f32 v212, v212, v254
    v_sub_f32 v213, v213, v254
    v_sub_f32 v214, v214, v254
    v_sub_f32 v215, v215, v254
    v_sub_f32 v255, 0, v254
    v_min_f32 v255, 0, v255
    v_exp_f32 v255, v255
    s_nop 0
    v_mul_f32 v245, v245, v255
    v_mov_b32 v249, v255
    v_max3_f32 v254, v176, v177, v178
    v_max3_f32 v254, v254, v179, v180
    v_max3_f32 v254, v254, v181, v182
    v_max_f32 v254, v254, v183
    v_mov_b32 v255, v254
    s_nop 0
    s_nop 0
    v_permlane32_swap_b32 v254, v255
    v_max_f32 v254, v254, v255
    v_mov_b32 v255, v254
    s_nop 0
    s_nop 0
    v_permlane16_swap_b32 v254, v255
    v_max_f32 v254, v254, v255
    v_max_f32 v254, s31, v254
    v_sub_f32 v176, v176, v254
    v_sub_f32 v177, v177, v254
    v_sub_f32 v178, v178, v254
    v_sub_f32 v179, v179, v254
    v_sub_f32 v180, v180, v254
    v_sub_f32 v181, v181, v254
    v_sub_f32 v182, v182, v254
    v_sub_f32 v183, v183, v254
    v_sub_f32 v216, v216, v254
    v_sub_f32 v217, v217, v254
    v_sub_f32 v218, v218, v254
    v_sub_f32 v219, v219, v254
    v_sub_f32 v255, 0, v254
    v_min_f32 v255, 0, v255
    v_exp_f32 v255, v255
    s_nop 0
    v_mul_f32 v246, v246, v255
    v_mov_b32 v250, v255
    v_max3_f32 v254, v184, v185, v186
    v_max3_f32 v254, v254, v187, v188
    v_max3_f32 v254, v254, v189, v190
    v_max_f32 v254, v254, v191
    v_mov_b32 v255, v254
    s_nop 0
    s_nop 0
    v_permlane32_swap_b32 v254, v255
    v_max_f32 v254, v254, v255
    v_mov_b32 v255, v254
    s_nop 0
    s_nop 0
    v_permlane16_swap_b32 v254, v255
    v_max_f32 v254, v254, v255
    v_max_f32 v254, s31, v254
    v_sub_f32 v184, v184, v254
    v_sub_f32 v185, v185, v254
    v_sub_f32 v186, v186, v254
    v_sub_f32 v187, v187, v254
    v_sub_f32 v188, v188, v254
    v_sub_f32 v189, v189, v254
    v_sub_f32 v190, v190, v254
    v_sub_f32 v191, v191, v254
    v_sub_f32 v220, v220, v254
    v_sub_f32 v221, v221, v254
    v_sub_f32 v222, v222, v254
    v_sub_f32 v223, v223, v254
    v_sub_f32 v255, 0, v254
    v_min_f32 v255, 0, v255
    v_exp_f32 v255, v255
    s_nop 0
    v_mul_f32 v247, v247, v255
    v_mov_b32 v251, v255
    s_mov_b32 s25, 1
    s_nop 1
    s_cmp_eq_u32 s30, 2
    s_cbranch_scc1 L_back_2
    s_cmp_eq_u32 s30, 6
    s_cbranch_scc1 L_back_6
    s_cmp_eq_u32 s30, 10
    s_cbranch_scc1 L_back_10
    s_cmp_eq_u32 s30, 14
    s_cbranch_scc1 L_back_14
    s_endpgm
L_R2:
    s_nop 15
    v_mul_f32 v0, v0, v248
    v_mul_f32 v1, v1, v248
    v_mul_f32 v2, v2, v248
    v_mul_f32 v3, v3, v248
    v_mul_f32 v4, v4, v248
    v_mul_f32 v5, v5, v248
    v_mul_f32 v6, v6, v248
    v_mul_f32 v7, v7, v248
    v_mul_f32 v8, v8, v248
    v_mul_f32 v9, v9, v248
    v_mul_f32 v10, v10, v248
    v_mul_f32 v11, v11, v248
    v_mul_f32 v12, v12, v248
    v_mul_f32 v13, v13, v248
    v_mul_f32 v14, v14, v248
    v_mul_f32 v15, v15, v248
    v_mul_f32 v16, v16, v248
    v_mul_f32 v17, v17, v248
    v_mul_f32 v18, v18, v248
    v_mul_f32 v19, v19, v248
    v_mul_f32 v20, v20, v248
    v_mul_f32 v21, v21, v248
    v_mul_f32 v22, v22, v248
    v_mul_f32 v23, v23, v248
    v_mul_f32 v24, v24, v248
    v_mul_f32 v25, v25, v248
    v_mul_f32 v26, v26, v248
    v_mul_f32 v27, v27, v248
    v_mul_f32 v28, v28, v248
    v_mul_f32 v29, v29, v248
    v_mul_f32 v30, v30, v248
    v_mul_f32 v31, v31, v248
    v_mul_f32 v32, v32, v248
    v_mul_f32 v33, v33, v248
    v_mul_f32 v34, v34, v248
    v_mul_f32 v35, v35, v248
    v_mul_f32 v36, v36, v248
    v_mul_f32 v37, v37, v248
    v_mul_f32 v38, v38, v248
    v_mul_f32 v39, v39, v248
    v_mul_f32 v40, v40, v248
    v_mul_f32 v41, v41, v248
    v_mul_f32 v42, v42, v248
    v_mul_f32 v43, v43, v248
    v_mul_f32 v44, v44, v248
    v_mul_f32 v45, v45, v248
    v_mul_f32 v46, v46, v248
    v_mul_f32 v47, v47, v248
    v_mul_f32 v48, v48, v248
    v_mul_f32 v49, v49, v248
    v_mul_f32 v50, v50, v248
    v_mul_f32 v51, v51, v248
    v_mul_f32 v52, v52, v248
    v_mul_f32 v53, v53, v248
    v_mul_f32 v54, v54, v248
    v_mul_f32 v55, v55, v248
    v_mul_f32 v56, v56, v248
    v_mul_f32 v57, v57, v248
    v_mul_f32 v58, v58, v248
    v_mul_f32 v59, v59, v248
    v_mul_f32 v60, v60, v248
    v_mul_f32 v61, v61, v248
    v_mul_f32 v62, v62, v248
    v_mul_f32 v63, v63, v248
    v_mul_f32 v64, v64, v249
    v_mul_f32 v65, v65, v249
    v_mul_f32 v66, v66, v249
    v_mul_f32 v67, v67, v249
    v_mul_f32 v68, v68, v249
    v_mul_f32 v69, v69, v249
    v_mul_f32 v70, v70, v249
    v_mul_f32 v71, v71, v249
    v_mul_f32 v72, v72, v249
    v_mul_f32 v73, v73, v249
    v_mul_f32 v74, v74, v249
    v_mul_f32 v75, v75, v249
    v_mul_f32 v76, v76, v249
    v_mul_f32 v77, v77, v249
    v_mul_f32 v78, v78, v249
    v_mul_f32 v79, v79, v249
    v_mul_f32 v80, v80, v249
    v_mul_f32 v81, v81, v249
    v_mul_f32 v82, v82, v249
    v_mul_f32 v83, v83, v249
    v_mul_f32 v84, v84, v249
    v_mul_f32 v85, v85, v249
    v_mul_f32 v86, v86, v249
    v_mul_f32 v87, v87, v249
    v_mul_f32 v88, v88, v249
    v_mul_f32 v89, v89, v249
    v_mul_f32 v90, v90, v249
    v_mul_f32 v91, v91, v249
    v_mul_f32 v92, v92, v249
    v_mul_f32 v93, v93, v249
    v_mul_f32 v94, v94, v249
    v_mul_f32 v95, v95, v249
    v_mul_f32 v96, v96, v249
    v_mul_f32 v97, v97, v249
    v_mul_f32 v98, v98, v249
    v_mul_f32 v99, v99, v249
    v_mul_f32 v100, v100, v249
    v_mul_f32 v101, v101, v249
    v_mul_f32 v102, v102, v249
    v_mul_f32 v103, v103, v249
    v_mul_f32 v104, v104, v249
    v_mul_f32 v105, v105, v249
    v_mul_f32 v106, v106, v249
    v_mul_f32 v107, v107, v249
    v_mul_f32 v108, v108, v249
    v_mul_f32 v109, v109, v249
    v_mul_f32 v110, v110, v249
    v_mul_f32 v111, v111, v249
    v_mul_f32 v112, v112, v249
    v_mul_f32 v113, v113, v249
    v_mul_f32 v114, v114, v249
    v_mul_f32 v115, v115, v249
    v_mul_f32 v116, v116, v249
    v_mul_f32 v117, v117, v249
    v_mul_f32 v118, v118, v249
    v_mul_f32 v119, v119, v249
    v_mul_f32 v120, v120, v249
    v_mul_f32 v121, v121, v249
    v_mul_f32 v122, v122, v249
    v_mul_f32 v123, v123, v249
    v_mul_f32 v124, v124, v249
    v_mul_f32 v125, v125, v249
    v_mul_f32 v126, v126, v249
    v_mul_f32 v127, v127, v249
    v_accvgpr_read_b32 v254, a0
    v_accvgpr_read_b32 v255, a1
    v_mul_f32 v254, v254, v250
    v_mul_f32 v255, v255, v250
    v_accvgpr_write_b32 a0, v254
    v_accvgpr_write_b32 a1, v255
    v_accvgpr_read_b32 v254, a2
    v_accvgpr_read_b32 v255, a3
    v_mul_f32 v254, v254, v250
    v_mul_f32 v255, v255, v250
    v_accvgpr_write_b32 a2, v254
    v_accvgpr_write_b32 a3, v255
    v_accvgpr_read_b32 v254, a4
    v_accvgpr_read_b32 v255, a5
    v_mul_f32 v254, v254, v250
    v_mul_f32 v255, v255, v250
    v_accvgpr_write_b32 a4, v254
    v_accvgpr_write_b32 a5, v255
    v_accvgpr_read_b32 v254, a6
    v_accvgpr_read_b32 v255, a7
    v_mul_f32 v254, v254, v250
    v_mul_f32 v255, v255, v250
    v_accvgpr_write_b32 a6, v254
    v_accvgpr_write_b32 a7, v255
    v_accvgpr_read_b32 v254, a8
    v_accvgpr_read_b32 v255, a9
    v_mul_f32 v254, v254, v250
    v_mul_f32 v255, v255, v250
    v_accvgpr_write_b32 a8, v254
    v_accvgpr_write_b32 a9, v255
    v_accvgpr_read_b32 v254, a10
    v_accvgpr_read_b32 v255, a11
    v_mul_f32 v254, v254, v250
    v_mul_f32 v255, v255, v250
    v_accvgpr_write_b32 a10, v254
    v_accvgpr_write_b32 a11, v255
    v_accvgpr_read_b32 v254, a12
    v_accvgpr_read_b32 v255, a13
    v_mul_f32 v254, v254, v250
    v_mul_f32 v255, v255, v250
    v_accvgpr_write_b32 a12, v254
    v_accvgpr_write_b32 a13, v255
    v_accvgpr_read_b32 v254, a14
    v_accvgpr_read_b32 v255, a15
    v_mul_f32 v254, v254, v250
    v_mul_f32 v255, v255, v250
    v_accvgpr_write_b32 a14, v254
    v_accvgpr_write_b32 a15, v255
    v_accvgpr_read_b32 v254, a16
    v_accvgpr_read_b32 v255, a17
    v_mul_f32 v254, v254, v250
    v_mul_f32 v255, v255, v250
    v_accvgpr_write_b32 a16, v254
    v_accvgpr_write_b32 a17, v255
    v_accvgpr_read_b32 v254, a18
    v_accvgpr_read_b32 v255, a19
    v_mul_f32 v254, v254, v250
    v_mul_f32 v255, v255, v250
    v_accvgpr_write_b32 a18, v254
    v_accvgpr_write_b32 a19, v255
    v_accvgpr_read_b32 v254, a20
    v_accvgpr_read_b32 v255, a21
    v_mul_f32 v254, v254, v250
    v_mul_f32 v255, v255, v250
    v_accvgpr_write_b32 a20, v254
    v_accvgpr_write_b32 a21, v255
    v_accvgpr_read_b32 v254, a22
    v_accvgpr_read_b32 v255, a23
    v_mul_f32 v254, v254, v250
    v_mul_f32 v255, v255, v250
    v_accvgpr_write_b32 a22, v254
    v_accvgpr_write_b32 a23, v255
    v_accvgpr_read_b32 v254, a24
    v_accvgpr_read_b32 v255, a25
    v_mul_f32 v254, v254, v250
    v_mul_f32 v255, v255, v250
    v_accvgpr_write_b32 a24, v254
    v_accvgpr_write_b32 a25, v255
    v_accvgpr_read_b32 v254, a26
    v_accvgpr_read_b32 v255, a27
    v_mul_f32 v254, v254, v250
    v_mul_f32 v255, v255, v250
    v_accvgpr_write_b32 a26, v254
    v_accvgpr_write_b32 a27, v255
    v_accvgpr_read_b32 v254, a28
    v_accvgpr_read_b32 v255, a29
    v_mul_f32 v254, v254, v250
    v_mul_f32 v255, v255, v250
    v_accvgpr_write_b32 a28, v254
    v_accvgpr_write_b32 a29, v255
    v_accvgpr_read_b32 v254, a30
    v_accvgpr_read_b32 v255, a31
    v_mul_f32 v254, v254, v250
    v_mul_f32 v255, v255, v250
    v_accvgpr_write_b32 a30, v254
    v_accvgpr_write_b32 a31, v255
    v_accvgpr_read_b32 v254, a32
    v_accvgpr_read_b32 v255, a33
    v_mul_f32 v254, v254, v250
    v_mul_f32 v255, v255, v250
    v_accvgpr_write_b32 a32, v254
    v_accvgpr_write_b32 a33, v255
    v_accvgpr_read_b32 v254, a34
    v_accvgpr_read_b32 v255, a35
    v_mul_f32 v254, v254, v250
    v_mul_f32 v255, v255, v250
    v_accvgpr_write_b32 a34, v254
    v_accvgpr_write_b32 a35, v255
    v_accvgpr_read_b32 v254, a36
    v_accvgpr_read_b32 v255, a37
    v_mul_f32 v254, v254, v250
    v_mul_f32 v255, v255, v250
    v_accvgpr_write_b32 a36, v254
    v_accvgpr_write_b32 a37, v255
    v_accvgpr_read_b32 v254, a38
    v_accvgpr_read_b32 v255, a39
    v_mul_f32 v254, v254, v250
    v_mul_f32 v255, v255, v250
    v_accvgpr_write_b32 a38, v254
    v_accvgpr_write_b32 a39, v255
    v_accvgpr_read_b32 v254, a40
    v_accvgpr_read_b32 v255, a41
    v_mul_f32 v254, v254, v250
    v_mul_f32 v255, v255, v250
    v_accvgpr_write_b32 a40, v254
    v_accvgpr_write_b32 a41, v255
    v_accvgpr_read_b32 v254, a42
    v_accvgpr_read_b32 v255, a43
    v_mul_f32 v254, v254, v250
    v_mul_f32 v255, v255, v250
    v_accvgpr_write_b32 a42, v254
    v_accvgpr_write_b32 a43, v255
    v_accvgpr_read_b32 v254, a44
    v_accvgpr_read_b32 v255, a45
    v_mul_f32 v254, v254, v250
    v_mul_f32 v255, v255, v250
    v_accvgpr_write_b32 a44, v254
    v_accvgpr_write_b32 a45, v255
    v_accvgpr_read_b32 v254, a46
    v_accvgpr_read_b32 v255, a47
    v_mul_f32 v254, v254, v250
    v_mul_f32 v255, v255, v250
    v_accvgpr_write_b32 a46, v254
    v_accvgpr_write_b32 a47, v255
    v_accvgpr_read_b32 v254, a48
    v_accvgpr_read_b32 v255, a49
    v_mul_f32 v254, v254, v250
    v_mul_f32 v255, v255, v250
    v_accvgpr_write_b32 a48, v254
    v_accvgpr_write_b32 a49, v255
    v_accvgpr_read_b32 v254, a50
    v_accvgpr_read_b32 v255, a51
    v_mul_f32 v254, v254, v250
    v_mul_f32 v255, v255, v250
    v_accvgpr_write_b32 a50, v254
    v_accvgpr_write_b32 a51, v255
    v_accvgpr_read_b32 v254, a52
    v_accvgpr_read_b32 v255, a53
    v_mul_f32 v254, v254, v250
    v_mul_f32 v255, v255, v250
    v_accvgpr_write_b32 a52, v254
    v_accvgpr_write_b32 a53, v255
    v_accvgpr_read_b32 v254, a54
    v_accvgpr_read_b32 v255, a55
    v_mul_f32 v254, v254, v250
    v_mul_f32 v255, v255, v250
    v_accvgpr_write_b32 a54, v254
    v_accvgpr_write_b32 a55, v255
    v_accvgpr_read_b32 v254, a56
    v_accvgpr_read_b32 v255, a57
    v_mul_f32 v254, v254, v250
    v_mul_f32 v255, v255, v250
    v_accvgpr_write_b32 a56, v254
    v_accvgpr_write_b32 a57, v255
    v_accvgpr_read_b32 v254, a58
    v_accvgpr_read_b32 v255, a59
    v_mul_f32 v254, v254, v250
    v_mul_f32 v255, v255, v250
    v_accvgpr_write_b32 a58, v254
    v_accvgpr_write_b32 a59, v255
    v_accvgpr_read_b32 v254, a60
    v_accvgpr_read_b32 v255, a61
    v_mul_f32 v254, v254, v250
    v_mul_f32 v255, v255, v250
    v_accvgpr_write_b32 a60, v254
    v_accvgpr_write_b32 a61, v255
    v_accvgpr_read_b32 v254, a62
    v_accvgpr_read_b32 v255, a63
    v_mul_f32 v254, v254, v250
    v_mul_f32 v255, v255, v250
    v_accvgpr_write_b32 a62, v254
    v_accvgpr_write_b32 a63, v255
    v_accvgpr_read_b32 v254, a64
    v_accvgpr_read_b32 v255, a65
    v_mul_f32 v254, v254, v251
    v_mul_f32 v255, v255, v251
    v_accvgpr_write_b32 a64, v254
    v_accvgpr_write_b32 a65, v255
    v_accvgpr_read_b32 v254, a66
    v_accvgpr_read_b32 v255, a67
    v_mul_f32 v254, v254, v251
    v_mul_f32 v255, v255, v251
    v_accvgpr_write_b32 a66, v254
    v_accvgpr_write_b32 a67, v255
    v_accvgpr_read_b32 v254, a68
    v_accvgpr_read_b32 v255, a69
    v_mul_f32 v254, v254, v251
    v_mul_f32 v255, v255, v251
    v_accvgpr_write_b32 a68, v254
    v_accvgpr_write_b32 a69, v255
    v_accvgpr_read_b32 v254, a70
    v_accvgpr_read_b32 v255, a71
    v_mul_f32 v254, v254, v251
    v_mul_f32 v255, v255, v251
    v_accvgpr_write_b32 a70, v254
    v_accvgpr_write_b32 a71, v255
    v_accvgpr_read_b32 v254, a72
    v_accvgpr_read_b32 v255, a73
    v_mul_f32 v254, v254, v251
    v_mul_f32 v255, v255, v251
    v_accvgpr_write_b32 a72, v254
    v_accvgpr_write_b32 a73, v255
    v_accvgpr_read_b32 v254, a74
    v_accvgpr_read_b32 v255, a75
    v_mul_f32 v254, v254, v251
    v_mul_f32 v255, v255, v251
    v_accvgpr_write_b32 a74, v254
    v_accvgpr_write_b32 a75, v255
    v_accvgpr_read_b32 v254, a76
    v_accvgpr_read_b32 v255, a77
    v_mul_f32 v254, v254, v251
    v_mul_f32 v255, v255, v251
    v_accvgpr_write_b32 a76, v254
    v_accvgpr_write_b32 a77, v255
    v_accvgpr_read_b32 v254, a78
    v_accvgpr_read_b32 v255, a79
    v_mul_f32 v254, v254, v251
    v_mul_f32 v255, v255, v251
    v_accvgpr_write_b32 a78, v254
    v_accvgpr_write_b32 a79, v255
    v_accvgpr_read_b32 v254, a80
    v_accvgpr_read_b32 v255, a81
    v_mul_f32 v254, v254, v251
    v_mul_f32 v255, v255, v251
    v_accvgpr_write_b32 a80, v254
    v_accvgpr_write_b32 a81, v255
    v_accvgpr_read_b32 v254, a82
    v_accvgpr_read_b32 v255, a83
    v_mul_f32 v254, v254, v251
    v_mul_f32 v255, v255, v251
    v_accvgpr_write_b32 a82, v254
    v_accvgpr_write_b32 a83, v255
    v_accvgpr_read_b32 v254, a84
    v_accvgpr_read_b32 v255, a85
    v_mul_f32 v254, v254, v251
    v_mul_f32 v255, v255, v251
    v_accvgpr_write_b32 a84, v254
    v_accvgpr_write_b32 a85, v255
    v_accvgpr_read_b32 v254, a86
    v_accvgpr_read_b32 v255, a87
    v_mul_f32 v254, v254, v251
    v_mul_f32 v255, v255, v251
    v_accvgpr_write_b32 a86, v254
    v_accvgpr_write_b32 a87, v255
    v_accvgpr_read_b32 v254, a88
    v_accvgpr_read_b32 v255, a89
    v_mul_f32 v254, v254, v251
    v_mul_f32 v255, v255, v251
    v_accvgpr_write_b32 a88, v254
    v_accvgpr_write_b32 a89, v255
    v_accvgpr_read_b32 v254, a90
    v_accvgpr_read_b32 v255, a91
    v_mul_f32 v254, v254, v251
    v_mul_f32 v255, v255, v251
    v_accvgpr_write_b32 a90, v254
    v_accvgpr_write_b32 a91, v255
    v_accvgpr_read_b32 v254, a92
    v_accvgpr_read_b32 v255, a93
    v_mul_f32 v254, v254, v251
    v_mul_f32 v255, v255, v251
    v_accvgpr_write_b32 a92, v254
    v_accvgpr_write_b32 a93, v255
    v_accvgpr_read_b32 v254, a94
    v_accvgpr_read_b32 v255, a95
    v_mul_f32 v254, v254, v251
    v_mul_f32 v255, v255, v251
    v_accvgpr_write_b32 a94, v254
    v_accvgpr_write_b32 a95, v255
    v_accvgpr_read_b32 v254, a96
    v_accvgpr_read_b32 v255, a97
    v_mul_f32 v254, v254, v251
    v_mul_f32 v255, v255, v251
    v_accvgpr_write_b32 a96, v254
    v_accvgpr_write_b32 a97, v255
    v_accvgpr_read_b32 v254, a98
    v_accvgpr_read_b32 v255, a99
    v_mul_f32 v254, v254, v251
    v_mul_f32 v255, v255, v251
    v_accvgpr_write_b32 a98, v254
    v_accvgpr_write_b32 a99, v255
    v_accvgpr_read_b32 v254, a100
    v_accvgpr_read_b32 v255, a101
    v_mul_f32 v254, v254, v251
    v_mul_f32 v255, v255, v251
    v_accvgpr_write_b32 a100, v254
    v_accvgpr_write_b32 a101, v255
    v_accvgpr_read_b32 v254, a102
    v_accvgpr_read_b32 v255, a103
    v_mul_f32 v254, v254, v251
    v_mul_f32 v255, v255, v251
    v_accvgpr_write_b32 a102, v254
    v_accvgpr_write_b32 a103, v255
    v_accvgpr_read_b32 v254, a104
    v_accvgpr_read_b32 v255, a105
    v_mul_f32 v254, v254, v251
    v_mul_f32 v255, v255, v251
    v_accvgpr_write_b32 a104, v254
    v_accvgpr_write_b32 a105, v255
    v_accvgpr_read_b32 v254, a106
    v_accvgpr_read_b32 v255, a107
    v_mul_f32 v254, v254, v251
    v_mul_f32 v255, v255, v251
    v_accvgpr_write_b32 a106, v254
    v_accvgpr_write_b32 a107, v255
    v_accvgpr_read_b32 v254, a108
    v_accvgpr_read_b32 v255, a109
    v_mul_f32 v254, v254, v251
    v_mul_f32 v255, v255, v251
    v_accvgpr_write_b32 a108, v254
    v_accvgpr_write_b32 a109, v255
    v_accvgpr_read_b32 v254, a110
    v_accvgpr_read_b32 v255, a111
    v_mul_f32 v254, v254, v251
    v_mul_f32 v255, v255, v251
    v_accvgpr_write_b32 a110, v254
    v_accvgpr_write_b32 a111, v255
    v_accvgpr_read_b32 v254, a112
    v_accvgpr_read_b32 v255, a113
    v_mul_f32 v254, v254, v251
    v_mul_f32 v255, v255, v251
    v_accvgpr_write_b32 a112, v254
    v_accvgpr_write_b32 a113, v255
    v_accvgpr_read_b32 v254, a114
    v_accvgpr_read_b32 v255, a115
    v_mul_f32 v254, v254, v251
    v_mul_f32 v255, v255, v251
    v_accvgpr_write_b32 a114, v254
    v_accvgpr_write_b32 a115, v255
    v_accvgpr_read_b32 v254, a116
    v_accvgpr_read_b32 v255, a117
    v_mul_f32 v254, v254, v251
    v_mul_f32 v255, v255, v251
    v_accvgpr_write_b32 a116, v254
    v_accvgpr_write_b32 a117, v255
    v_accvgpr_read_b32 v254, a118
    v_accvgpr_read_b32 v255, a119
    v_mul_f32 v254, v254, v251
    v_mul_f32 v255, v255, v251
    v_accvgpr_write_b32 a118, v254
    v_accvgpr_write_b32 a119, v255
    v_accvgpr_read_b32 v254, a120
    v_accvgpr_read_b32 v255, a121
    v_mul_f32 v254, v254, v251
    v_mul_f32 v255, v255, v251
    v_accvgpr_write_b32 a120, v254
    v_accvgpr_write_b32 a121, v255
    v_accvgpr_read_b32 v254, a122
    v_accvgpr_read_b32 v255, a123
    v_mul_f32 v254, v254, v251
    v_mul_f32 v255, v255, v251
    v_accvgpr_write_b32 a122, v254
    v_accvgpr_write_b32 a123, v255
    v_accvgpr_read_b32 v254, a124
    v_accvgpr_read_b32 v255, a125
    v_mul_f32 v254, v254, v251
    v_mul_f32 v255, v255, v251
    v_accvgpr_write_b32 a124, v254
    v_accvgpr_write_b32 a125, v255
    v_accvgpr_read_b32 v254, a126
    v_accvgpr_read_b32 v255, a127
    v_mul_f32 v254, v254, v251
    v_mul_f32 v255, v255, v251
    v_accvgpr_write_b32 a126, v254
    v_accvgpr_write_b32 a127, v255
    v_mov_b32 v248, 1.0
    v_mov_b32 v249, 1.0
    v_mov_b32 v250, 1.0
    v_mov_b32 v251, 1.0
    s_mov_b32 s25, 0
    s_nop 1
    s_cmp_eq_u32 s30, 1
    s_cbranch_scc1 L_back_1
    s_cmp_eq_u32 s30, 3
    s_cbranch_scc1 L_back_3
    s_cmp_eq_u32 s30, 5
    s_cbranch_scc1 L_back_5
    s_cmp_eq_u32 s30, 7
    s_cbranch_scc1 L_back_7
    s_cmp_eq_u32 s30, 9
    s_cbranch_scc1 L_back_9
    s_cmp_eq_u32 s30, 11
    s_cbranch_scc1 L_back_11
    s_cmp_eq_u32 s30, 13
    s_cbranch_scc1 L_back_13
    s_cmp_eq_u32 s30, 15
    s_cbranch_scc1 L_back_15
    s_endpgm
.section .rodata,"a"
.p2align 6
.amdhsa_kernel standalone__mha_softmax__near_ridge_kernel
  .amdhsa_next_free_vgpr 512
  .amdhsa_next_free_sgpr 96
  .amdhsa_accum_offset 256
  .amdhsa_group_segment_fixed_size 0
  .amdhsa_kernarg_size 48
  .amdhsa_user_sgpr_count 2
  .amdhsa_user_sgpr_kernarg_segment_ptr 1
  .amdhsa_system_sgpr_workgroup_id_x 1
.end_amdhsa_kernel
```
